```python
import torch

def _softmax(x, axis=-1):
    return torch.softmax(x, dim=axis)
def _gelu(x):
    return torch.nn.functional.gelu(x, approximate="tanh")
def _silu(x):
    return torch.nn.functional.silu(x)
def _sigmoid(x):
    return torch.sigmoid(x)
def _layernorm(x, axis=-1, eps=1e-5):
    m = x.mean(dim=axis, keepdim=True)
    v = x.var(dim=axis, keepdim=True, unbiased=False)
    return (x - m) / torch.sqrt(v + eps)
def _scatter_add(tgt, idx, src, axis=0):
    return tgt.clone().index_add_(axis, idx, src)
def _segment_sum(src, seg, n):
    out = torch.zeros((n,) + src.shape[1:], dtype=src.dtype)
    return out.index_add_(0, seg, src)
def _pad(x, pw):
    flat = tuple(v for pair in reversed(pw) for v in pair)
    return torch.nn.functional.pad(x, flat)

kernel_name = 'gated_mix__linear_kernel_hedgehog__grouped_kv_mqa__prompt'

def setup_inputs():

    _w = (lambda a: (lambda t: t.to(torch.bfloat16) if t.is_floating_point() else t)(torch.as_tensor(a)))
    def _A_setup():
        B, S, D, H = 1, 2048, 512, 32
        Dh = D // H
        return {
            "x": _w((lambda *s: torch.randn(*s, dtype=torch.bfloat16) * 0.05)(B, S, D)),
            "wqkv": _w((lambda *s: torch.randn(*s, dtype=torch.bfloat16) * 1.6)(D, 3 * D)),
            "w_phi": _w((lambda *s: torch.randn(*s, dtype=torch.bfloat16) * 1.6)(H, Dh, Dh) * (Dh ** -0.5)),
            "wo": _w((lambda *s: torch.randn(*s, dtype=torch.bfloat16) * 0.4)(D, D)),
        }
    _A_in = _A_setup()

    def _B_setup():
        B, S, D, H = 1, 2048, 512, 32
        Dh = D // H
        return {
            "x": _w((lambda *s: torch.randn(*s, dtype=torch.bfloat16) * 0.05)(B, S, D)),
            "wq": _w((lambda *s: torch.randn(*s, dtype=torch.bfloat16) * 3.2)(D, H * Dh)),
            "wk": _w((lambda *s: torch.randn(*s, dtype=torch.bfloat16) * 3.2)(D, Dh)),
            "wv": _w((lambda *s: torch.randn(*s, dtype=torch.bfloat16) * 0.1)(D, Dh)),
            "wo": _w((lambda *s: torch.randn(*s, dtype=torch.bfloat16) * 0.1)(H * Dh, D)),
        }
    _B_in = _B_setup()

    return {
        "A_x": _A_in["x"],
        "A_wqkv": _A_in["wqkv"],
        "A_w_phi": _A_in["w_phi"],
        "A_wo": _A_in["wo"],
        "B_x": _B_in["x"],
        "B_wq": _B_in["wq"],
        "B_wk": _B_in["wk"],
        "B_wv": _B_in["wv"],
        "B_wo": _B_in["wo"],
        "gate_w": _w((lambda *s: torch.randn(*s, dtype=torch.bfloat16) * 0.05)(512) * 16.0),
    }

def reference(A_x, A_wqkv, A_w_phi, A_wo, B_x, B_wq, B_wk, B_wv, B_wo, gate_w):
    def _A_ref(x, wqkv, w_phi, wo):
        B, S, D = x.shape
        H = 32; Dh = D // H
        qkv = (lambda x, *d: x.permute(*d))((x @ wqkv).reshape(B, S, 3, H, Dh), 2, 0, 3, 1, 4)
        q, k, v = qkv[0], qkv[1], qkv[2]
        pq = torch.einsum("bhsd,hdf->bhsf", q, w_phi)
        pk = torch.einsum("bhsd,hdf->bhsf", k, w_phi)
        phi_q = torch.concatenate([_softmax(pq, axis=-1), _softmax(-pq, axis=-1)], axis=-1)
        phi_k = torch.concatenate([_softmax(pk, axis=-1), _softmax(-pk, axis=-1)], axis=-1)
        kv = torch.einsum("bhsf,bhsd->bhfd", phi_k, v)
        z  = torch.einsum("bhsf->bhf", phi_k)
        num = torch.einsum("bhqf,bhfd->bhqd", phi_q, kv)
        den = torch.einsum("bhqf,bhf->bhq", phi_q, z)[..., None] + 1e-6
        o = num / den
        return (lambda x, *d: x.permute(*d))(o, 0, 2, 1, 3).reshape(B, S, D) @ wo

    def _B_ref(x, wq, wk, wv, wo):
        B, S, D = x.shape
        H = 32
        Dh = D // H
        q = (lambda x, *d: x.permute(*d))((x @ wq).reshape(B, S, H, Dh), 0, 2, 1, 3)
        k = x @ wk
        v = x @ wv
        scores = torch.einsum("bhqd,bkd->bhqk", q, k) * (Dh ** -0.5)
        p = _softmax(scores, axis=-1)
        o = torch.einsum("bhqk,bkd->bhqd", p, v)
        return (lambda x, *d: x.permute(*d))(o, 0, 2, 1, 3).reshape(B, S, H * Dh) @ wo

    x = A_x
    g = _sigmoid((x * gate_w).sum(-1, keepdims=True))
    a = _A_ref(x, A_wqkv, A_w_phi, A_wo)
    b = _B_ref(x, B_wq, B_wk, B_wv, B_wo)
    return g * a + (1 - g) * b
```

```asm
; @launch grid=(256,1,1) block=(768,1,1) lds=158720
.amdgcn_target "amdgcn-amd-amdhsa--gfx950"
.text
.globl gated_mix__linear_kernel_hedgehog__grouped_kv_mqa__prompt_kernel
.p2align 8
.type gated_mix__linear_kernel_hedgehog__grouped_kv_mqa__prompt_kernel,@function
gated_mix__linear_kernel_hedgehog__grouped_kv_mqa__prompt_kernel:
    s_cmp_ge_u32 s2, 256
    s_cbranch_scc1 L_done
    s_load_dwordx16 s[48:63], s[0:1], 0
    s_load_dwordx8 s[64:71], s[0:1], 64
    s_load_dwordx2 s[72:73], s[0:1], 96
    v_and_b32 v1, 63, v0
    v_lshrrev_b32 v11, 6, v0
    s_nop 0
    v_readfirstlane_b32 s30, v11
    s_and_b32 s36, s2, 7
    s_lshr_b32 s37, s2, 3
    s_and_b32 s29, s36, 1
    s_lshl_b32 s29, s29, 2
    s_lshr_b32 s38, s37, 3
    s_or_b32 s29, s29, s38
    s_lshr_b32 s28, s36, 1
    s_lshl_b32 s28, s28, 3
    s_and_b32 s38, s37, 7
    s_add_u32 s28, s28, s38
    s_lshl_b32 s31, s29, 1
    s_add_u32 s31, s31, s28
    s_and_b32 s31, s31, 7
    s_lshl_b32 s3, s29, 1
    s_lshr_b32 s3, 0x1bff, s3
    s_and_b32 s3, s3, 3
    v_lshlrev_b32 v10, 4, v1
    s_cmp_lt_u32 s30, 8
    s_cbranch_scc1 L_compute
    s_setprio 3
    s_sub_u32 s30, s30, 8
    v_lshrrev_b32 v11, 3, v1
    v_and_b32 v12, 7, v1
    v_lshrrev_b32 v13, 4, v1
    v_xor_b32 v14, v12, v13
    v_lshlrev_b32 v14, 4, v14
    v_lshl_add_u32 v2, v11, 10, v14
    v_xor_b32 v3, 64, v2
    v_add_u32 v3, 7168, v3
    s_lshl_b32 s32, s28, 16
    s_lshl_b32 s38, s30, 14
    s_add_u32 s32, s32, s38
    s_lshl_b32 s41, s30, 11
    s_lshl_b32 s40, s30, 12
    s_mov_b32 s36, s31
    s_mov_b32 s6, 0x200000
    s_mov_b32 s7, 0x00020000
    s_waitcnt lgkmcnt(0)
    s_mov_b32 s4, s48
    s_mov_b32 s5, s49
    s_lshl_b32 s38, s31, 7
    s_add_u32 s38, s38, s32
    s_add_u32 m0, s41, 65536
    s_add_u32 s31, s31, 1
    buffer_load_dwordx4 v2, s[4:7], s38 offen offset:0 lds
    buffer_load_dwordx4 v3, s[4:7], s38 offen offset:1024 lds
    s_and_b32 s31, s31, 7
    s_lshl_b32 s38, s31, 7
    s_add_u32 s38, s38, s32
    s_add_u32 m0, s41, 73728
    s_add_u32 s31, s31, 1
    buffer_load_dwordx4 v2, s[4:7], s38 offen offset:0 lds
    buffer_load_dwordx4 v3, s[4:7], s38 offen offset:1024 lds
    s_and_b32 s31, s31, 7
    s_cmp_gt_u32 s3, 2
    s_cbranch_scc1 L_noext
    s_cmp_eq_u32 s3, 0
    s_cselect_b32 s16, s60, s62
    s_cselect_b32 s17, s61, s63
    s_cmp_eq_u32 s3, 2
    s_cselect_b32 s16, s66, s16
    s_cselect_b32 s17, s67, s17
    s_mov_b32 s18, 16384
    s_cselect_b32 s18, 1024, s18
    s_mov_b32 s19, 0x00020000
    s_mov_b32 m0, s40
    s_nop 0
    buffer_load_dwordx4 v10, s[16:19], s40 offen offset:0 lds
    buffer_load_dwordx4 v10, s[16:19], s40 offen offset:1024 lds
    buffer_load_dwordx4 v10, s[16:19], s40 offen offset:2048 lds
    buffer_load_dwordx4 v10, s[16:19], s40 offen offset:3072 lds
L_noext:
    s_lshl_b32 s38, s31, 7
    s_add_u32 s38, s38, s32
    s_add_u32 m0, s41, 81920
    s_add_u32 s31, s31, 1
    buffer_load_dwordx4 v2, s[4:7], s38 offen offset:0 lds
    buffer_load_dwordx4 v3, s[4:7], s38 offen offset:1024 lds
    s_and_b32 s31, s31, 7
    s_lshl_b32 s38, s31, 7
    s_add_u32 s38, s38, s32
    s_add_u32 m0, s41, 90112
    s_add_u32 s31, s31, 1
    buffer_load_dwordx4 v2, s[4:7], s38 offen offset:0 lds
    buffer_load_dwordx4 v3, s[4:7], s38 offen offset:1024 lds
    s_and_b32 s31, s31, 7
    s_lshl_b32 s38, s31, 7
    s_add_u32 s38, s38, s32
    s_add_u32 m0, s41, 98304
    s_add_u32 s31, s31, 1
    buffer_load_dwordx4 v2, s[4:7], s38 offen offset:0 lds
    buffer_load_dwordx4 v3, s[4:7], s38 offen offset:1024 lds
    s_and_b32 s31, s31, 7
    s_lshl_b32 s38, s31, 7
    s_add_u32 s38, s38, s32
    s_add_u32 m0, s41, 106496
    s_add_u32 s31, s31, 1
    buffer_load_dwordx4 v2, s[4:7], s38 offen offset:0 lds
    buffer_load_dwordx4 v3, s[4:7], s38 offen offset:1024 lds
    s_and_b32 s31, s31, 7
    v_and_b32 v13, 1, v13
    v_lshlrev_b32 v13, 1, v13
    v_xor_b32 v14, v12, v13
    v_lshlrev_b32 v14, 4, v14
    v_mul_u32_u24 v6, 3072, v11
    v_add_u32 v6, v6, v14
    v_add_u32 v7, 23552, v6
    v_xor_b32 v8, 64, v6
    v_add_u32 v9, 23552, v8
    s_lshl_b32 s38, s29, 7
    s_mul_i32 s33, s30, 49152
    s_add_u32 s33, s33, s38
    v_xor_b32 v14, 64, v14
    v_lshl_add_u32 v4, v11, 10, v14
    v_add_u32 v5, 7168, v4
    s_lshl_b32 s34, s30, 14
    s_add_u32 s34, s34, s38
    s_mov_b32 s8, s50
    s_mov_b32 s9, s51
    s_mov_b32 s10, 0x180000
    s_mov_b32 s11, 0x00020000
    s_mov_b32 s12, s58
    s_mov_b32 s13, s59
    s_mov_b32 s14, 0x80000
    s_mov_b32 s15, 0x00020000
    s_load_dwordx2 s[78:79], s[72:73], 0x24800
    s_mov_b32 s20, s52
    s_mov_b32 s21, s53
    s_mov_b32 s22, 0x4000
    s_mov_b32 s23, 0x00020000
    s_mov_b32 s24, s72
    s_mov_b32 s25, s73
    s_mov_b32 s26, 0xb00000
    s_mov_b32 s27, 0x00020000
    s_and_b32 s46, s30, 1
    s_lshr_b32 s47, s30, 1
    v_bfe_u32 v13, v1, 4, 1
    v_lshlrev_b32 v15, 2, v13
    v_xor_b32 v15, v12, v15
    v_lshlrev_b32 v15, 4, v15
    v_lshl_add_u32 v144, v11, 10, v15
    v_add_u32 v145, 7168, v144
    v_add_u32 v146, 14336, v144
    v_add_u32 v147, 21504, v144
    v_lshrrev_b32 v16, 5, v1
    v_bfe_u32 v15, v1, 2, 2
    v_lshl_add_u32 v148, v16, 2, v15
    v_lshlrev_b32 v148, 7, v148
    v_lshrrev_b32 v15, 1, v15
    v_xor_b32 v15, s47, v15
    v_lshl_add_u32 v148, v15, 6, v148
    v_lshl_add_u32 v148, v13, 5, v148
    v_and_b32 v15, 3, v1
    v_lshl_add_u32 v148, v15, 3, v148
    s_lshl_b32 s38, s47, 15
    v_add_u32 v148, s38, v148
    v_xor_b32 v149, 64, v148
    s_add_u32 s38, s40, 131072
    v_add_u32 v150, s38, v10
    v_xor_b32 v151, 0x2000, v150
    v_and_b32 v155, 31, v1
    v_lshlrev_b32 v152, 10, v155
    v_lshl_add_u32 v152, v16, 4, v152
    v_lshlrev_b32 v155, 2, v155
    v_and_b32 v153, 15, v1
    v_lshlrev_b32 v153, 3, v153
    v_lshl_add_u32 v153, v16, 7, v153
    s_lshl_b32 s38, s30, 9
    s_add_u32 s38, s38, 155648
    v_add_u32 v153, s38, v153
    s_add_u32 s38, s41, 131072
    v_add_u32 v154, s38, v10
    v_lshlrev_b32 v156, 3, v1
    v_and_b32 v150, 31, v1
    v_mul_u32_u24 v150, 272, v150
    v_lshl_add_u32 v150, v16, 4, v150
    s_mul_i32 s38, s47, 17408
    s_mul_i32 s39, s46, 8704
    s_add_u32 s38, s38, s39
    s_lshl_b32 s39, s47, 7
    s_add_u32 s39, s39, s38
    s_xor_b32 s37, s47, 1
    s_lshl_b32 s37, s37, 7
    s_add_u32 s38, s38, s37
    v_add_u32 v151, s38, v150
    v_add_u32 v150, s39, v150
    v_mul_u32_u24 v157, 272, v11
    v_lshl_add_u32 v157, v12, 5, v157
    s_mul_i32 s38, s30, 4352
    v_add_u32 v157, s38, v157
    v_lshlrev_b32 v152, 10, v11
    v_lshl_add_u32 v152, v12, 4, v152
    s_mov_b32 s37, 0
    s_mov_b32 s74, 0x3fb8aa3b
    s_mov_b32 s75, 0xbfb8aa3b
    v_and_b32 v15, 31, v1
    v_lshlrev_b32 v15, 3, v15
    s_lshl_b32 s38, s30, 8
    s_add_u32 s38, s38, 180224
    v_add_u32 v15, s38, v15
    s_lshl_b32 s42, s30, 10
    s_and_b32 s38, s30, 1
    s_lshl_b32 s38, s38, 10
    s_add_u32 m0, s38, 155648
    s_lshl_b32 s39, s29, 11
    s_add_u32 s38, s38, s39
    buffer_load_dwordx4 v10, s[20:23], s38 offen lds
    s_waitcnt vmcnt(9)
    s_barrier
    s_lshl_b32 s38, s31, 7
    s_add_u32 s38, s38, s32
    s_add_u32 m0, s41, 114688
    s_add_u32 s31, s31, 1
    buffer_load_dwordx4 v2, s[4:7], s38 offen offset:0 lds
    buffer_load_dwordx4 v3, s[4:7], s38 offen offset:1024 lds
    s_and_b32 s31, s31, 7
    s_lshl_b32 s38, s31, 7
    s_add_u32 s38, s38, s32
    s_add_u32 m0, s41, 122880
    s_add_u32 s31, s31, 1
    buffer_load_dwordx4 v2, s[4:7], s38 offen offset:0 lds
    buffer_load_dwordx4 v3, s[4:7], s38 offen offset:1024 lds
    s_and_b32 s31, s31, 7
    s_waitcnt vmcnt(9)
    s_barrier
    s_add_u32 s35, s36, 0
    s_and_b32 s35, s35, 7
    s_mul_i32 s39, s35, 196608
    s_add_u32 s39, s39, s33
    s_add_u32 m0, s41, 16384
    s_add_u32 s39, s39, 1024
    buffer_load_dwordx4 v6, s[8:11], s39 offen offset:0 lds
    buffer_load_dwordx4 v7, s[8:11], s39 offen offset:1024 lds
    s_add_u32 m0, s41, 24576
    s_add_u32 s39, s39, 1024
    buffer_load_dwordx4 v8, s[8:11], s39 offen offset:0 lds
    buffer_load_dwordx4 v9, s[8:11], s39 offen offset:1024 lds
    s_waitcnt vmcnt(9)
    s_barrier
    s_add_u32 s35, s36, 1
    s_and_b32 s35, s35, 7
    s_mul_i32 s39, s35, 196608
    s_add_u32 s39, s39, s33
    s_add_u32 m0, s41, 32768
    s_add_u32 s39, s39, 1024
    buffer_load_dwordx4 v6, s[8:11], s39 offen offset:0 lds
    buffer_load_dwordx4 v7, s[8:11], s39 offen offset:1024 lds
    s_add_u32 m0, s41, 40960
    s_add_u32 s39, s39, 1024
    buffer_load_dwordx4 v8, s[8:11], s39 offen offset:0 lds
    buffer_load_dwordx4 v9, s[8:11], s39 offen offset:1024 lds
    s_waitcnt vmcnt(8)
    s_barrier
    s_add_u32 s35, s36, 2
    s_and_b32 s35, s35, 7
    s_mul_i32 s39, s35, 196608
    s_add_u32 s39, s39, s33
    s_add_u32 m0, s41, 49152
    s_add_u32 s39, s39, 1024
    buffer_load_dwordx4 v6, s[8:11], s39 offen offset:0 lds
    buffer_load_dwordx4 v7, s[8:11], s39 offen offset:1024 lds
    s_add_u32 m0, s41, 57344
    s_add_u32 s39, s39, 1024
    buffer_load_dwordx4 v8, s[8:11], s39 offen offset:0 lds
    buffer_load_dwordx4 v9, s[8:11], s39 offen offset:1024 lds
    s_waitcnt vmcnt(8)
    s_barrier
    s_add_u32 s35, s36, 3
    s_and_b32 s35, s35, 7
    s_mul_i32 s39, s35, 196608
    s_add_u32 s39, s39, s33
    s_add_u32 m0, s41, 0
    s_add_u32 s39, s39, 1024
    buffer_load_dwordx4 v6, s[8:11], s39 offen offset:0 lds
    buffer_load_dwordx4 v7, s[8:11], s39 offen offset:1024 lds
    s_add_u32 m0, s41, 8192
    s_add_u32 s39, s39, 1024
    buffer_load_dwordx4 v8, s[8:11], s39 offen offset:0 lds
    buffer_load_dwordx4 v9, s[8:11], s39 offen offset:1024 lds
    s_waitcnt vmcnt(8)
    s_barrier
    s_add_u32 s35, s36, 4
    s_and_b32 s35, s35, 7
    s_mul_i32 s39, s35, 196608
    s_add_u32 s39, s39, s33
    s_add_u32 m0, s41, 16384
    s_add_u32 s39, s39, 1024
    buffer_load_dwordx4 v6, s[8:11], s39 offen offset:0 lds
    buffer_load_dwordx4 v7, s[8:11], s39 offen offset:1024 lds
    s_add_u32 m0, s41, 24576
    s_add_u32 s39, s39, 1024
    buffer_load_dwordx4 v8, s[8:11], s39 offen offset:0 lds
    buffer_load_dwordx4 v9, s[8:11], s39 offen offset:1024 lds
    s_waitcnt vmcnt(8)
    s_barrier
    s_add_u32 s35, s36, 5
    s_and_b32 s35, s35, 7
    s_mul_i32 s39, s35, 196608
    s_add_u32 s39, s39, s33
    s_add_u32 m0, s41, 32768
    s_add_u32 s39, s39, 1024
    buffer_load_dwordx4 v6, s[8:11], s39 offen offset:0 lds
    buffer_load_dwordx4 v7, s[8:11], s39 offen offset:1024 lds
    s_add_u32 m0, s41, 40960
    s_add_u32 s39, s39, 1024
    buffer_load_dwordx4 v8, s[8:11], s39 offen offset:0 lds
    buffer_load_dwordx4 v9, s[8:11], s39 offen offset:1024 lds
    s_waitcnt vmcnt(8)
    s_barrier
    s_add_u32 s35, s36, 6
    s_and_b32 s35, s35, 7
    s_mul_i32 s39, s35, 196608
    s_add_u32 s39, s39, s33
    s_add_u32 m0, s41, 49152
    s_add_u32 s39, s39, 1024
    buffer_load_dwordx4 v6, s[8:11], s39 offen offset:0 lds
    buffer_load_dwordx4 v7, s[8:11], s39 offen offset:1024 lds
    s_add_u32 m0, s41, 57344
    s_add_u32 s39, s39, 1024
    buffer_load_dwordx4 v8, s[8:11], s39 offen offset:0 lds
    buffer_load_dwordx4 v9, s[8:11], s39 offen offset:1024 lds
    s_waitcnt vmcnt(8)
    s_barrier
    s_waitcnt lgkmcnt(0)
    s_add_u32 s78, s78, 1
    s_add_u32 s35, s36, 7
    s_and_b32 s35, s35, 7
    s_mul_i32 s39, s35, 196608
    s_add_u32 s39, s39, s33
    s_add_u32 m0, s41, 0
    s_add_u32 s39, s39, 1024
    buffer_load_dwordx4 v6, s[8:11], s39 offen offset:0 lds
    buffer_load_dwordx4 v7, s[8:11], s39 offen offset:1024 lds
    s_add_u32 m0, s41, 8192
    s_add_u32 s39, s39, 1024
    buffer_load_dwordx4 v8, s[8:11], s39 offen offset:0 lds
    buffer_load_dwordx4 v9, s[8:11], s39 offen offset:1024 lds
    s_waitcnt vmcnt(8)
    s_barrier
    s_add_u32 s35, s36, 0
    s_and_b32 s35, s35, 7
    s_mul_i32 s39, s35, 196608
    s_add_u32 s39, s39, s33
    s_add_u32 m0, s41, 131072
    s_lshl_b32 s38, s35, 16
    buffer_load_dwordx4 v6, s[8:11], s39 offen offset:0 lds
    buffer_load_dwordx4 v7, s[8:11], s39 offen offset:1024 lds
    s_add_u32 m0, s41, 139264
    s_add_u32 s38, s38, s34
    buffer_load_dwordx4 v4, s[12:15], s38 offen offset:0 lds
    buffer_load_dwordx4 v5, s[12:15], s38 offen offset:1024 lds
    s_waitcnt vmcnt(8)
    s_barrier
    s_add_u32 s35, s36, 1
    s_and_b32 s35, s35, 7
    s_mul_i32 s39, s35, 196608
    s_add_u32 s39, s39, s33
    s_add_u32 m0, s41, 16384
    s_lshl_b32 s38, s35, 16
    buffer_load_dwordx4 v6, s[8:11], s39 offen offset:0 lds
    buffer_load_dwordx4 v7, s[8:11], s39 offen offset:1024 lds
    s_add_u32 m0, s41, 24576
    s_add_u32 s38, s38, s34
    buffer_load_dwordx4 v4, s[12:15], s38 offen offset:0 lds
    buffer_load_dwordx4 v5, s[12:15], s38 offen offset:1024 lds
    s_waitcnt vmcnt(8)
    s_barrier
    s_add_u32 s35, s36, 2
    s_and_b32 s35, s35, 7
    s_mul_i32 s39, s35, 196608
    s_add_u32 s39, s39, s33
    s_add_u32 m0, s41, 32768
    s_lshl_b32 s38, s35, 16
    buffer_load_dwordx4 v6, s[8:11], s39 offen offset:0 lds
    buffer_load_dwordx4 v7, s[8:11], s39 offen offset:1024 lds
    s_add_u32 m0, s41, 40960
    s_add_u32 s38, s38, s34
    buffer_load_dwordx4 v4, s[12:15], s38 offen offset:0 lds
    buffer_load_dwordx4 v5, s[12:15], s38 offen offset:1024 lds
    s_waitcnt vmcnt(8)
    s_barrier
    s_add_u32 s35, s36, 3
    s_and_b32 s35, s35, 7
    s_mul_i32 s39, s35, 196608
    s_add_u32 s39, s39, s33
    s_add_u32 m0, s41, 49152
    s_lshl_b32 s38, s35, 16
    buffer_load_dwordx4 v6, s[8:11], s39 offen offset:0 lds
    buffer_load_dwordx4 v7, s[8:11], s39 offen offset:1024 lds
    s_add_u32 m0, s41, 57344
    s_add_u32 s38, s38, s34
    buffer_load_dwordx4 v4, s[12:15], s38 offen offset:0 lds
    buffer_load_dwordx4 v5, s[12:15], s38 offen offset:1024 lds
    s_waitcnt vmcnt(8)
    s_barrier
    s_add_u32 s35, s36, 4
    s_and_b32 s35, s35, 7
    s_mul_i32 s39, s35, 196608
    s_add_u32 s39, s39, s33
    s_add_u32 m0, s41, 0
    s_lshl_b32 s38, s35, 16
    buffer_load_dwordx4 v6, s[8:11], s39 offen offset:0 lds
    buffer_load_dwordx4 v7, s[8:11], s39 offen offset:1024 lds
    s_add_u32 m0, s41, 8192
    s_add_u32 s38, s38, s34
    buffer_load_dwordx4 v4, s[12:15], s38 offen offset:0 lds
    buffer_load_dwordx4 v5, s[12:15], s38 offen offset:1024 lds
    s_waitcnt vmcnt(8)
    s_barrier
    s_add_u32 s35, s36, 5
    s_and_b32 s35, s35, 7
    s_mul_i32 s39, s35, 196608
    s_add_u32 s39, s39, s33
    s_add_u32 m0, s41, 16384
    s_lshl_b32 s38, s35, 16
    buffer_load_dwordx4 v6, s[8:11], s39 offen offset:0 lds
    buffer_load_dwordx4 v7, s[8:11], s39 offen offset:1024 lds
    s_add_u32 m0, s41, 24576
    s_add_u32 s38, s38, s34
    buffer_load_dwordx4 v4, s[12:15], s38 offen offset:0 lds
    buffer_load_dwordx4 v5, s[12:15], s38 offen offset:1024 lds
    buffer_load_dwordx2 v[16:17], v15, s[24:27], 0 offen sc1
    s_waitcnt vmcnt(9)
    s_barrier
    s_add_u32 s35, s36, 6
    s_and_b32 s35, s35, 7
    s_mul_i32 s39, s35, 196608
    s_add_u32 s39, s39, s33
    s_add_u32 m0, s41, 32768
    s_lshl_b32 s38, s35, 16
    buffer_load_dwordx4 v6, s[8:11], s39 offen offset:0 lds
    buffer_load_dwordx4 v7, s[8:11], s39 offen offset:1024 lds
    s_add_u32 m0, s41, 40960
    s_add_u32 s38, s38, s34
    buffer_load_dwordx4 v4, s[12:15], s38 offen offset:0 lds
    buffer_load_dwordx4 v5, s[12:15], s38 offen offset:1024 lds
    s_waitcnt vmcnt(9)
    s_barrier
    s_add_u32 s35, s36, 7
    s_and_b32 s35, s35, 7
    s_mul_i32 s39, s35, 196608
    s_add_u32 s39, s39, s33
    s_add_u32 m0, s41, 49152
    s_lshl_b32 s38, s35, 16
    buffer_load_dwordx4 v6, s[8:11], s39 offen offset:0 lds
    buffer_load_dwordx4 v7, s[8:11], s39 offen offset:1024 lds
    s_add_u32 m0, s41, 57344
    s_add_u32 s38, s38, s34
    buffer_load_dwordx4 v4, s[12:15], s38 offen offset:0 lds
    buffer_load_dwordx4 v5, s[12:15], s38 offen offset:1024 lds
    s_waitcnt vmcnt(9)
    s_barrier
    s_waitcnt vmcnt(8)
    v_cmp_ne_u64 vcc, s[78:79], v[16:17]
    s_cbranch_vccnz L_kvlate
    s_mov_b32 m0, s42
    s_nop 0
    buffer_load_dwordx4 v10, s[24:27], s42 offen sc1 lds
    s_add_u32 s42, s42, 4096
    s_mov_b32 m0, s42
    s_nop 0
    buffer_load_dwordx4 v10, s[24:27], s42 offen sc1 lds
    s_add_u32 s42, s42, 4096
    s_mov_b32 m0, s42
    s_nop 0
    buffer_load_dwordx4 v10, s[24:27], s42 offen sc1 lds
    s_add_u32 s42, s42, 4096
    s_mov_b32 m0, s42
    s_nop 0
    buffer_load_dwordx4 v10, s[24:27], s42 offen sc1 lds
    s_add_u32 s42, s42, 4096
    s_waitcnt vmcnt(8)
    s_barrier
    s_mov_b32 m0, s42
    s_nop 0
    buffer_load_dwordx4 v10, s[24:27], s42 offen sc1 lds
    s_add_u32 s42, s42, 4096
    s_mov_b32 m0, s42
    s_nop 0
    buffer_load_dwordx4 v10, s[24:27], s42 offen sc1 lds
    s_add_u32 s42, s42, 4096
    s_mov_b32 m0, s42
    s_nop 0
    buffer_load_dwordx4 v10, s[24:27], s42 offen sc1 lds
    s_add_u32 s42, s42, 4096
    s_mov_b32 m0, s42
    s_nop 0
    buffer_load_dwordx4 v10, s[24:27], s42 offen sc1 lds
    s_add_u32 s42, s42, 4096
    s_waitcnt vmcnt(8)
    s_barrier
    s_mov_b32 m0, s42
    s_nop 0
    buffer_load_dwordx4 v10, s[24:27], s42 offen sc1 lds
    s_add_u32 s42, s42, 4096
    s_mov_b32 m0, s42
    s_nop 0
    buffer_load_dwordx4 v10, s[24:27], s42 offen sc1 lds
    s_add_u32 s42, s42, 4096
    s_mov_b32 m0, s42
    s_nop 0
    buffer_load_dwordx4 v10, s[24:27], s42 offen sc1 lds
    s_add_u32 s42, s42, 4096
    s_mov_b32 m0, s42
    s_nop 0
    buffer_load_dwordx4 v10, s[24:27], s42 offen sc1 lds
    s_add_u32 s42, s42, 4096
L_kv20:
    s_waitcnt vmcnt(4)
    s_barrier
    s_branch L_kvjoin
L_kvlate:
    buffer_load_dwordx2 v[16:17], v15, s[24:27], 0 offen sc1
    s_waitcnt vmcnt(5)
    s_barrier
    s_waitcnt vmcnt(1)
    s_barrier
    s_waitcnt vmcnt(0)
    v_cmp_ne_u64 vcc, s[78:79], v[16:17]
    s_cbranch_vccz L_kvlate2
    s_mov_b32 s77, 0
FP_1:
    buffer_load_dwordx2 v[16:17], v15, s[24:27], 0 offen sc1
    s_add_u32 s77, s77, 1
    s_waitcnt vmcnt(0)
    v_cmp_ne_u64 vcc, s[78:79], v[16:17]
    s_cbranch_vccz FD_2
    s_cmp_gt_u32 s77, 65536
    s_cbranch_scc1 FD_2
    s_sleep 2
    s_branch FP_1
FD_2:
L_kvlate2:
    s_mov_b32 m0, s42
    s_nop 0
    buffer_load_dwordx4 v10, s[24:27], s42 offen sc1 lds
    s_add_u32 s42, s42, 4096
    s_mov_b32 m0, s42
    s_nop 0
    buffer_load_dwordx4 v10, s[24:27], s42 offen sc1 lds
    s_add_u32 s42, s42, 4096
    s_mov_b32 m0, s42
    s_nop 0
    buffer_load_dwordx4 v10, s[24:27], s42 offen sc1 lds
    s_add_u32 s42, s42, 4096
    s_mov_b32 m0, s42
    s_nop 0
    buffer_load_dwordx4 v10, s[24:27], s42 offen sc1 lds
    s_add_u32 s42, s42, 4096
    s_mov_b32 m0, s42
    s_nop 0
    buffer_load_dwordx4 v10, s[24:27], s42 offen sc1 lds
    s_add_u32 s42, s42, 4096
    s_mov_b32 m0, s42
    s_nop 0
    buffer_load_dwordx4 v10, s[24:27], s42 offen sc1 lds
    s_add_u32 s42, s42, 4096
    s_mov_b32 m0, s42
    s_nop 0
    buffer_load_dwordx4 v10, s[24:27], s42 offen sc1 lds
    s_add_u32 s42, s42, 4096
    s_mov_b32 m0, s42
    s_nop 0
    buffer_load_dwordx4 v10, s[24:27], s42 offen sc1 lds
    s_add_u32 s42, s42, 4096
    s_mov_b32 m0, s42
    s_nop 0
    buffer_load_dwordx4 v10, s[24:27], s42 offen sc1 lds
    s_add_u32 s42, s42, 4096
    s_mov_b32 m0, s42
    s_nop 0
    buffer_load_dwordx4 v10, s[24:27], s42 offen sc1 lds
    s_add_u32 s42, s42, 4096
    s_mov_b32 m0, s42
    s_nop 0
    buffer_load_dwordx4 v10, s[24:27], s42 offen sc1 lds
    s_add_u32 s42, s42, 4096
    s_mov_b32 m0, s42
    s_nop 0
    buffer_load_dwordx4 v10, s[24:27], s42 offen sc1 lds
    s_add_u32 s42, s42, 4096
    s_branch L_kv20
L_kvjoin:
    s_mov_b32 m0, s42
    s_nop 0
    buffer_load_dwordx4 v10, s[24:27], s42 offen sc1 lds
    s_add_u32 s42, s42, 4096
    s_mov_b32 m0, s42
    s_nop 0
    buffer_load_dwordx4 v10, s[24:27], s42 offen sc1 lds
    s_add_u32 s42, s42, 4096
    s_mov_b32 m0, s42
    s_nop 0
    buffer_load_dwordx4 v10, s[24:27], s42 offen sc1 lds
    s_add_u32 s42, s42, 4096
    s_mov_b32 m0, s42
    s_nop 0
    buffer_load_dwordx4 v10, s[24:27], s42 offen sc1 lds
    s_add_u32 s42, s42, 4096
    s_mov_b32 m0, s42
    s_nop 0
    buffer_load_dwordx4 v10, s[24:27], s42 offen sc1 lds
    s_add_u32 s42, s42, 4096
    s_mov_b32 m0, s42
    s_nop 0
    buffer_load_dwordx4 v10, s[24:27], s42 offen sc1 lds
    s_add_u32 s42, s42, 4096
    s_mov_b32 m0, s42
    s_nop 0
    buffer_load_dwordx4 v10, s[24:27], s42 offen sc1 lds
    s_add_u32 s42, s42, 4096
    s_mov_b32 m0, s42
    s_nop 0
    buffer_load_dwordx4 v10, s[24:27], s42 offen sc1 lds
    s_add_u32 s42, s42, 4096
    s_mov_b32 m0, s42
    s_nop 0
    buffer_load_dwordx4 v10, s[24:27], s42 offen sc1 lds
    s_add_u32 s42, s42, 4096
    s_mov_b32 m0, s42
    s_nop 0
    buffer_load_dwordx4 v10, s[24:27], s42 offen sc1 lds
    s_add_u32 s42, s42, 4096
    s_mov_b32 m0, s42
    s_nop 0
    buffer_load_dwordx4 v10, s[24:27], s42 offen sc1 lds
    s_add_u32 s42, s42, 4096
    s_mov_b32 m0, s42
    s_nop 0
    buffer_load_dwordx4 v10, s[24:27], s42 offen sc1 lds
    s_add_u32 s42, s42, 4096
    s_mov_b32 m0, s42
    s_nop 0
    buffer_load_dwordx4 v10, s[24:27], s42 offen sc1 lds
    s_add_u32 s42, s42, 4096
    s_mov_b32 m0, s42
    s_nop 0
    buffer_load_dwordx4 v10, s[24:27], s42 offen sc1 lds
    s_add_u32 s42, s42, 4096
    s_mov_b32 m0, s42
    s_nop 0
    buffer_load_dwordx4 v10, s[24:27], s42 offen sc1 lds
    s_add_u32 s42, s42, 4096
    s_mov_b32 m0, s42
    s_nop 0
    buffer_load_dwordx4 v10, s[24:27], s42 offen sc1 lds
    s_add_u32 s42, s42, 4096
    s_mov_b32 m0, s42
    s_nop 0
    buffer_load_dwordx4 v10, s[24:27], s42 offen sc1 lds
    s_add_u32 s42, s42, 4096
    s_mov_b32 m0, s42
    s_nop 0
    buffer_load_dwordx4 v10, s[24:27], s42 offen sc1 lds
    s_add_u32 s42, s42, 4096
    s_mov_b32 m0, s42
    s_nop 0
    buffer_load_dwordx4 v10, s[24:27], s42 offen sc1 lds
    s_add_u32 s42, s42, 4096
    s_mov_b32 m0, s42
    s_nop 0
    buffer_load_dwordx4 v10, s[24:27], s42 offen sc1 lds
    s_add_u32 s42, s42, 4096
    ds_read_b128 v[16:19], v154 offset:0
    ds_read_b128 v[24:27], v154 offset:1024
    ds_read_b64_tr_b16 v[32:33], v153 offset:0
    ds_read_b64_tr_b16 v[34:35], v153 offset:256
    s_lshl_b32 s38, s28, 4
    s_add_u32 s38, s38, 148480
    v_and_b32 v46, 8, v156
    v_add_u32 v46, s38, v46
    s_waitcnt vmcnt(0)
    v_mov_b32 v42, 157696
    v_mov_b32 v43, 1
    s_mov_b64 exec, 1
    ds_add_u32 v42, v43
    s_mov_b64 exec, -1
    s_lshl_b32 s45, s29, 2
    s_lshl_b32 s36, s28, 7
    s_add_u32 s36, s36, s45
    s_add_u32 s36, s36, s30
    s_lshl_b32 s36, s36, 10
    s_add_u32 s36, s36, 5242880
    v_mov_b64 v[48:49], -1
    v_mov_b64 v[50:51], -1
    s_add_u32 s38, s36, 32768
    buffer_store_dwordx4 v[48:51], v10, s[24:27], s38 offen sc1
    s_add_u32 s38, s36, 98304
    buffer_store_dwordx4 v[48:51], v10, s[24:27], s38 offen sc1
    s_mov_b32 s77, 0
FP_3:
    buffer_load_dwordx2 v[44:45], v46, s[24:27], 0 offen sc1
    s_add_u32 s77, s77, 1
    s_waitcnt vmcnt(0)
    v_cmp_ne_u64 vcc, s[78:79], v[44:45]
    s_cbranch_vccz FD_4
    s_cmp_gt_u32 s77, 65536
    s_cbranch_scc1 FD_4
    s_sleep 4
    s_branch FP_3
FD_4:
    s_lshl_b32 s38, s28, 8
    s_add_u32 s38, s38, 131072
    buffer_load_dword v40, v155, s[24:27], s38 offen sc1
    buffer_load_dword v41, v155, s[24:27], s38 offen offset:128 sc1
    s_waitcnt lgkmcnt(0)
    v_mfma_f32_32x32x16_bf16 v[48:63], v[32:35], v[16:19], 0
    v_mfma_f32_32x32x16_bf16 v[64:79], v[32:35], v[24:27], 0
    s_nop 10
    v_max3_f32 v80, v48, v49, v50
    v_max3_f32 v84, v64, v65, v66
    v_max3_f32 v82, -v48, -v49, -v50
    v_max3_f32 v86, -v64, -v65, -v66
    v_max3_f32 v80, v80, v51, v52
    v_max3_f32 v84, v84, v67, v68
    v_max3_f32 v82, v82, -v51, -v52
    v_max3_f32 v86, v86, -v67, -v68
    v_max3_f32 v80, v80, v53, v54
    v_max3_f32 v84, v84, v69, v70
    v_max3_f32 v82, v82, -v53, -v54
    v_max3_f32 v86, v86, -v69, -v70
    v_max_f32 v80, v80, v55
    v_max_f32 v84, v84, v71
    v_max_f32_e64 v82, v82, -v55
    v_max_f32_e64 v86, v86, -v71
    s_nop 0
    v_permlane32_swap_b32 v80, v82
    v_permlane32_swap_b32 v84, v86
    s_nop 1
    v_max_f32 v80, v80, v82
    v_max_f32 v84, v84, v86
    v_mul_f32 v80, s75, v80
    v_mul_f32 v84, s75, v84
    v_mov_b32 v82, v80
    v_mov_b32 v86, v84
    s_nop 0
    v_permlane32_swap_b32 v80, v82
    v_permlane32_swap_b32 v84, v86
    s_nop 1
    v_pk_fma_f32 v[56:57], v[48:49], s[74:75], v[82:83] op_sel_hi:[1,0,0] neg_lo:[1,0,0] neg_hi:[1,0,0]
    v_pk_fma_f32 v[72:73], v[64:65], s[74:75], v[86:87] op_sel_hi:[1,0,0] neg_lo:[1,0,0] neg_hi:[1,0,0]
    v_pk_fma_f32 v[48:49], v[48:49], s[74:75], v[80:81] op_sel_hi:[1,0,0]
    v_pk_fma_f32 v[64:65], v[64:65], s[74:75], v[84:85] op_sel_hi:[1,0,0]
    v_pk_fma_f32 v[58:59], v[50:51], s[74:75], v[82:83] op_sel_hi:[1,0,0] neg_lo:[1,0,0] neg_hi:[1,0,0]
    v_pk_fma_f32 v[74:75], v[66:67], s[74:75], v[86:87] op_sel_hi:[1,0,0] neg_lo:[1,0,0] neg_hi:[1,0,0]
    v_pk_fma_f32 v[50:51], v[50:51], s[74:75], v[80:81] op_sel_hi:[1,0,0]
    v_pk_fma_f32 v[66:67], v[66:67], s[74:75], v[84:85] op_sel_hi:[1,0,0]
    v_pk_fma_f32 v[60:61], v[52:53], s[74:75], v[82:83] op_sel_hi:[1,0,0] neg_lo:[1,0,0] neg_hi:[1,0,0]
    v_pk_fma_f32 v[76:77], v[68:69], s[74:75], v[86:87] op_sel_hi:[1,0,0] neg_lo:[1,0,0] neg_hi:[1,0,0]
    v_pk_fma_f32 v[52:53], v[52:53], s[74:75], v[80:81] op_sel_hi:[1,0,0]
    v_pk_fma_f32 v[68:69], v[68:69], s[74:75], v[84:85] op_sel_hi:[1,0,0]
    v_pk_fma_f32 v[62:63], v[54:55], s[74:75], v[82:83] op_sel_hi:[1,0,0] neg_lo:[1,0,0] neg_hi:[1,0,0]
    v_pk_fma_f32 v[78:79], v[70:71], s[74:75], v[86:87] op_sel_hi:[1,0,0] neg_lo:[1,0,0] neg_hi:[1,0,0]
    v_pk_fma_f32 v[54:55], v[54:55], s[74:75], v[80:81] op_sel_hi:[1,0,0]
    v_pk_fma_f32 v[70:71], v[70:71], s[74:75], v[84:85] op_sel_hi:[1,0,0]
    v_exp_f32 v48, v48
    v_exp_f32 v64, v64
    v_exp_f32 v49, v49
    v_exp_f32 v65, v65
    v_exp_f32 v50, v50
    v_exp_f32 v66, v66
    v_exp_f32 v51, v51
    v_exp_f32 v67, v67
    v_exp_f32 v52, v52
    v_exp_f32 v68, v68
    v_exp_f32 v53, v53
    v_exp_f32 v69, v69
    v_exp_f32 v54, v54
    v_exp_f32 v70, v70
    v_exp_f32 v55, v55
    v_exp_f32 v71, v71
    v_exp_f32 v56, v56
    v_exp_f32 v72, v72
    v_exp_f32 v57, v57
    v_exp_f32 v73, v73
    v_exp_f32 v58, v58
    v_exp_f32 v74, v74
    v_exp_f32 v59, v59
    v_exp_f32 v75, v75
    v_exp_f32 v60, v60
    v_exp_f32 v76, v76
    v_exp_f32 v61, v61
    v_exp_f32 v77, v77
    v_exp_f32 v62, v62
    v_exp_f32 v78, v78
    v_exp_f32 v63, v63
    v_exp_f32 v79, v79
    v_pk_add_f32 v[16:17], v[48:49], v[50:51]
    v_pk_add_f32 v[24:25], v[64:65], v[66:67]
    v_pk_add_f32 v[18:19], v[52:53], v[54:55]
    v_pk_add_f32 v[26:27], v[68:69], v[70:71]
    v_pk_add_f32 v[20:21], v[56:57], v[58:59]
    v_pk_add_f32 v[28:29], v[72:73], v[74:75]
    v_pk_add_f32 v[22:23], v[60:61], v[62:63]
    v_pk_add_f32 v[30:31], v[76:77], v[78:79]
    v_pk_add_f32 v[16:17], v[16:17], v[18:19]
    v_pk_add_f32 v[24:25], v[24:25], v[26:27]
    v_pk_add_f32 v[20:21], v[20:21], v[22:23]
    v_pk_add_f32 v[28:29], v[28:29], v[30:31]
    v_add_f32 v80, v16, v17
    v_add_f32 v84, v24, v25
    v_add_f32 v82, v20, v21
    v_add_f32 v86, v28, v29
    s_nop 0
    v_permlane32_swap_b32 v80, v82
    v_permlane32_swap_b32 v84, v86
    s_nop 1
    v_add_f32 v80, v80, v82
    v_add_f32 v84, v84, v86
    v_rcp_f32 v80, v80
    v_rcp_f32 v84, v84
    v_mov_b32 v82, v80
    v_mov_b32 v86, v84
    s_nop 0
    v_permlane32_swap_b32 v80, v82
    v_permlane32_swap_b32 v84, v86
    s_nop 1
    v_pk_mul_f32 v[48:49], v[48:49], v[80:81] op_sel_hi:[1,0]
    v_pk_mul_f32 v[64:65], v[64:65], v[84:85] op_sel_hi:[1,0]
    v_pk_mul_f32 v[56:57], v[56:57], v[82:83] op_sel_hi:[1,0]
    v_pk_mul_f32 v[72:73], v[72:73], v[86:87] op_sel_hi:[1,0]
    v_pk_mul_f32 v[50:51], v[50:51], v[80:81] op_sel_hi:[1,0]
    v_pk_mul_f32 v[66:67], v[66:67], v[84:85] op_sel_hi:[1,0]
    v_pk_mul_f32 v[58:59], v[58:59], v[82:83] op_sel_hi:[1,0]
    v_pk_mul_f32 v[74:75], v[74:75], v[86:87] op_sel_hi:[1,0]
    v_pk_mul_f32 v[52:53], v[52:53], v[80:81] op_sel_hi:[1,0]
    v_pk_mul_f32 v[68:69], v[68:69], v[84:85] op_sel_hi:[1,0]
    v_pk_mul_f32 v[60:61], v[60:61], v[82:83] op_sel_hi:[1,0]
    v_pk_mul_f32 v[76:77], v[76:77], v[86:87] op_sel_hi:[1,0]
    v_pk_mul_f32 v[54:55], v[54:55], v[80:81] op_sel_hi:[1,0]
    v_pk_mul_f32 v[70:71], v[70:71], v[84:85] op_sel_hi:[1,0]
    v_pk_mul_f32 v[62:63], v[62:63], v[82:83] op_sel_hi:[1,0]
    v_pk_mul_f32 v[78:79], v[78:79], v[86:87] op_sel_hi:[1,0]
    v_cvt_pk_bf16_f32 v16, v48, v49
    v_cvt_pk_bf16_f32 v24, v64, v65
    v_cvt_pk_bf16_f32 v17, v50, v51
    v_cvt_pk_bf16_f32 v25, v66, v67
    v_cvt_pk_bf16_f32 v18, v52, v53
    v_cvt_pk_bf16_f32 v26, v68, v69
    v_cvt_pk_bf16_f32 v19, v54, v55
    v_cvt_pk_bf16_f32 v27, v70, v71
    v_cvt_pk_bf16_f32 v20, v56, v57
    v_cvt_pk_bf16_f32 v28, v72, v73
    v_cvt_pk_bf16_f32 v21, v58, v59
    v_cvt_pk_bf16_f32 v29, v74, v75
    v_cvt_pk_bf16_f32 v22, v60, v61
    v_cvt_pk_bf16_f32 v30, v76, v77
    v_cvt_pk_bf16_f32 v23, v62, v63
    v_cvt_pk_bf16_f32 v31, v78, v79
    v_add_u32 v42, 157760, v155
    s_waitcnt vmcnt(0)
    ds_write_b32 v42, v40
    ds_write_b32 v42, v41 offset:128
    s_waitcnt lgkmcnt(0)
    v_mov_b32 v42, 157708
    v_mov_b32 v43, 1
    s_mov_b64 exec, 1
    ds_add_u32 v42, v43
    s_mov_b64 exec, -1
    s_and_b32 s38, s28, 3
    s_cmp_lg_u32 s38, s30
    s_cbranch_scc1 L_nored
    s_lshr_b32 s38, s28, 3
    s_add_u32 s43, s45, s38
    v_lshlrev_b32 v15, 1, v155
    s_lshl_b32 s38, s43, 8
    s_add_u32 s38, s38, 151552
    v_add_u32 v42, s38, v15
    s_mov_b32 s77, 0
FP_5:
    buffer_load_dwordx2 v[44:45], v42, s[24:27], 0 offen sc1
    s_add_u32 s77, s77, 1
    s_waitcnt vmcnt(0)
    v_cmp_ne_u64 vcc, s[78:79], v[44:45]
    s_cbranch_vccz FD_6
    s_cmp_gt_u32 s77, 65536
    s_cbranch_scc1 FD_6
    s_sleep 4
    s_branch FP_5
FD_6:
    s_lshl_b32 s43, s43, 3
    s_and_b32 s38, s28, 7
    s_add_u32 s43, s43, s38
    s_lshl_b32 s38, s43, 14
    s_add_u32 s38, s38, 1048576
    v_min_u32 v42, 64, v155
    v_and_b32 v43, 0x200, v10
    v_lshl_add_u32 v42, v42, 2, v43
    buffer_load_dwordx4 v[80:83], v42, s[24:27], s38 offen offset:0 sc1
    buffer_load_dwordx4 v[84:87], v42, s[24:27], s38 offen offset:1024 sc1
    buffer_load_dwordx4 v[88:91], v42, s[24:27], s38 offen offset:2048 sc1
    buffer_load_dwordx4 v[92:95], v42, s[24:27], s38 offen offset:3072 sc1
    s_add_u32 s38, s38, 4096
    buffer_load_dwordx4 v[96:99], v42, s[24:27], s38 offen offset:0 sc1
    buffer_load_dwordx4 v[100:103], v42, s[24:27], s38 offen offset:1024 sc1
    buffer_load_dwordx4 v[104:107], v42, s[24:27], s38 offen offset:2048 sc1
    buffer_load_dwordx4 v[108:111], v42, s[24:27], s38 offen offset:3072 sc1
    s_add_u32 s38, s38, 4096
    buffer_load_dwordx4 v[112:115], v42, s[24:27], s38 offen offset:0 sc1
    buffer_load_dwordx4 v[116:119], v42, s[24:27], s38 offen offset:1024 sc1
    buffer_load_dwordx4 v[120:123], v42, s[24:27], s38 offen offset:2048 sc1
    buffer_load_dwordx4 v[124:127], v42, s[24:27], s38 offen offset:3072 sc1
    s_add_u32 s38, s38, 4096
    buffer_load_dwordx4 v[128:131], v42, s[24:27], s38 offen offset:0 sc1
    buffer_load_dwordx4 v[132:135], v42, s[24:27], s38 offen offset:1024 sc1
    buffer_load_dwordx4 v[136:139], v42, s[24:27], s38 offen offset:2048 sc1
    buffer_load_dwordx4 v[140:143], v42, s[24:27], s38 offen offset:3072 sc1
    s_waitcnt vmcnt(0)
    v_pk_add_f32 v[80:81], v[80:81], v[112:113]
    v_pk_add_f32 v[82:83], v[82:83], v[114:115]
    v_pk_add_f32 v[84:85], v[84:85], v[116:117]
    v_pk_add_f32 v[86:87], v[86:87], v[118:119]
    v_pk_add_f32 v[88:89], v[88:89], v[120:121]
    v_pk_add_f32 v[90:91], v[90:91], v[122:123]
    v_pk_add_f32 v[92:93], v[92:93], v[124:125]
    v_pk_add_f32 v[94:95], v[94:95], v[126:127]
    v_pk_add_f32 v[96:97], v[96:97], v[128:129]
    v_pk_add_f32 v[98:99], v[98:99], v[130:131]
    v_pk_add_f32 v[100:101], v[100:101], v[132:133]
    v_pk_add_f32 v[102:103], v[102:103], v[134:135]
    v_pk_add_f32 v[104:105], v[104:105], v[136:137]
    v_pk_add_f32 v[106:107], v[106:107], v[138:139]
    v_pk_add_f32 v[108:109], v[108:109], v[140:141]
    v_pk_add_f32 v[110:111], v[110:111], v[142:143]
    v_pk_add_f32 v[80:81], v[80:81], v[96:97]
    v_pk_add_f32 v[82:83], v[82:83], v[98:99]
    v_pk_add_f32 v[84:85], v[84:85], v[100:101]
    v_pk_add_f32 v[86:87], v[86:87], v[102:103]
    v_pk_add_f32 v[88:89], v[88:89], v[104:105]
    v_pk_add_f32 v[90:91], v[90:91], v[106:107]
    v_pk_add_f32 v[92:93], v[92:93], v[108:109]
    v_pk_add_f32 v[94:95], v[94:95], v[110:111]
    v_pk_add_f32 v[80:81], v[80:81], v[88:89]
    v_pk_add_f32 v[82:83], v[82:83], v[90:91]
    v_pk_add_f32 v[84:85], v[84:85], v[92:93]
    v_pk_add_f32 v[86:87], v[86:87], v[94:95]
    v_pk_add_f32 v[80:81], v[80:81], v[84:85]
    v_pk_add_f32 v[82:83], v[82:83], v[86:87]
    s_nop 1
    v_permlane32_swap_b32 v80, v82
    v_permlane32_swap_b32 v81, v83
    s_nop 2
    v_pk_add_f32 v[80:81], v[80:81], v[82:83]
    v_cvt_pk_bf16_f32 v80, v80, v81
    v_lshrrev_b32 v42, 5, v1
    v_lshl_add_u32 v42, v42, 2, v15
    s_lshl_b32 s38, s43, 8
    s_add_u32 s38, s38, 196608
    buffer_store_dword v80, v42, s[24:27], s38 offen sc1
    s_lshl_b32 s38, s43, 3
    s_add_u32 s38, s38, 159744
    s_waitcnt vmcnt(0)
    v_mov_b32 v42, s78
    v_mov_b32 v43, s79
    v_mov_b32 v44, 0
    s_mov_b64 exec, 1
    buffer_store_dwordx2 v[42:43], v44, s[24:27], s38 offen sc1
    s_mov_b64 exec, -1
L_nored:
    s_add_u32 s45, s45, s30
    s_lshl_b32 s38, s45, 6
    s_add_u32 s38, s38, 159744
    v_and_b32 v42, 56, v156
    v_add_u32 v42, s38, v42
    s_mov_b32 s77, 0
FP_7:
    buffer_load_dwordx2 v[44:45], v42, s[24:27], 0 offen sc1
    s_add_u32 s77, s77, 1
    s_waitcnt vmcnt(0)
    v_cmp_ne_u64 vcc, s[78:79], v[44:45]
    s_cbranch_vccz FD_8
    s_cmp_gt_u32 s77, 65536
    s_cbranch_scc1 FD_8
    s_sleep 4
    s_branch FP_7
FD_8:
    s_lshl_b32 s38, s45, 11
    s_add_u32 s38, s38, 196608
    buffer_load_dwordx2 v[32:33], v156, s[24:27], s38 offen offset:0 sc1
    buffer_load_dwordx2 v[34:35], v156, s[24:27], s38 offen offset:512 sc1
    buffer_load_dwordx2 v[36:37], v156, s[24:27], s38 offen offset:1024 sc1
    buffer_load_dwordx2 v[38:39], v156, s[24:27], s38 offen offset:1536 sc1
    s_waitcnt vmcnt(0)
    v_mfma_f32_32x32x16_bf16 v[48:63], v[32:35], v[16:19], 0
    v_mfma_f32_32x32x16_bf16 v[64:79], v[32:35], v[24:27], 0
    v_mfma_f32_32x32x16_bf16 v[48:63], v[36:39], v[20:23], v[48:63]
    v_mfma_f32_32x32x16_bf16 v[64:79], v[36:39], v[28:31], v[64:79]
    s_nop 10
    v_add_f32 v42, 0x358637bd, v56
    v_rcp_f32 v42, v42
    s_nop 0
    v_mul_f32 v42, v42, v40
    v_pk_mul_f32 v[48:49], v[48:49], v[42:43] op_sel_hi:[1,0]
    v_pk_mul_f32 v[50:51], v[50:51], v[42:43] op_sel_hi:[1,0]
    v_pk_mul_f32 v[52:53], v[52:53], v[42:43] op_sel_hi:[1,0]
    v_pk_mul_f32 v[54:55], v[54:55], v[42:43] op_sel_hi:[1,0]
    v_cvt_pk_bf16_f32 v48, v48, v49
    v_cvt_pk_bf16_f32 v49, v50, v51
    v_cvt_pk_bf16_f32 v50, v52, v53
    v_cvt_pk_bf16_f32 v51, v54, v55
    v_add_f32 v42, 0x358637bd, v72
    v_rcp_f32 v42, v42
    s_nop 0
    v_mul_f32 v42, v42, v41
    v_pk_mul_f32 v[64:65], v[64:65], v[42:43] op_sel_hi:[1,0]
    v_pk_mul_f32 v[66:67], v[66:67], v[42:43] op_sel_hi:[1,0]
    v_pk_mul_f32 v[68:69], v[68:69], v[42:43] op_sel_hi:[1,0]
    v_pk_mul_f32 v[70:71], v[70:71], v[42:43] op_sel_hi:[1,0]
    v_cvt_pk_bf16_f32 v64, v64, v65
    v_cvt_pk_bf16_f32 v65, v66, v67
    v_cvt_pk_bf16_f32 v66, v68, v69
    v_cvt_pk_bf16_f32 v67, v70, v71
    s_add_u32 s38, s36, 65536
    buffer_store_dwordx4 v[48:51], v10, s[24:27], s36 offen sc1
    buffer_store_dwordx4 v[64:67], v10, s[24:27], s38 offen sc1
    s_lshl_b32 s38, s28, 5
    s_add_u32 s38, s38, s45
    s_lshl_b32 s38, s38, 3
    s_add_u32 s38, s38, 188416
    s_waitcnt vmcnt(0)
    v_mov_b32 v42, s78
    v_mov_b32 v43, s79
    v_mov_b32 v44, 0
    s_mov_b64 exec, 1
    buffer_store_dwordx2 v[42:43], v44, s[24:27], s38 offen sc1
    s_mov_b64 exec, -1
    s_mov_b32 s4, s54
    s_mov_b32 s5, s55
    s_mov_b32 s6, 0x80000
    s_mov_b32 s7, 0x00020000
    s_mov_b32 s8, s64
    s_mov_b32 s9, s65
    s_mov_b32 s10, 0x80000
    s_mov_b32 s11, 0x00020000
    s_mov_b32 s12, s68
    s_mov_b32 s13, s69
    s_mov_b32 s14, 0x200000
    s_mov_b32 s15, 0x00020000
    s_lshl_b32 s44, s28, 1
    s_add_u32 s44, s44, s46
    s_lshl_b32 s43, s44, 16
    s_lshl_b32 s38, s47, 14
    s_add_u32 s43, s43, s38
    s_add_u32 s43, s43, 5242880
    v_mov_b32 v128, 157700
    s_mov_b32 s77, 0
LW_9:
    ds_read_b32 v129, v128
    s_add_u32 s77, s77, 1
    s_waitcnt lgkmcnt(0)
    v_cmp_gt_u32 vcc, 8, v129
    s_cbranch_vccz LD_10
    s_cmp_gt_u32 s77, 524288
    s_cbranch_scc1 LD_10
    s_sleep 8
    s_branch LW_9
LD_10:
    s_lshl_b32 s38, s30, 17
    s_lshl_b32 s39, s29, 7
    s_add_u32 s38, s38, s39
    s_lshl_b32 s39, s30, 14
    s_mov_b32 m0, s39
    s_nop 0
    buffer_load_dwordx4 v144, s[4:7], s38 offen offset:0 lds
    buffer_load_dwordx4 v145, s[4:7], s38 offen offset:1024 lds
    buffer_load_dwordx4 v146, s[4:7], s38 offen offset:2048 lds
    buffer_load_dwordx4 v147, s[4:7], s38 offen offset:3072 lds
    s_add_u32 s38, s38, 32768
    s_add_u32 s39, s39, 4096
    s_mov_b32 m0, s39
    s_nop 0
    buffer_load_dwordx4 v144, s[4:7], s38 offen offset:0 lds
    buffer_load_dwordx4 v145, s[4:7], s38 offen offset:1024 lds
    buffer_load_dwordx4 v146, s[4:7], s38 offen offset:2048 lds
    buffer_load_dwordx4 v147, s[4:7], s38 offen offset:3072 lds
    s_add_u32 s38, s38, 32768
    s_add_u32 s39, s39, 4096
    s_mov_b32 m0, s39
    s_nop 0
    buffer_load_dwordx4 v144, s[4:7], s38 offen offset:0 lds
    buffer_load_dwordx4 v145, s[4:7], s38 offen offset:1024 lds
    buffer_load_dwordx4 v146, s[4:7], s38 offen offset:2048 lds
    buffer_load_dwordx4 v147, s[4:7], s38 offen offset:3072 lds
    s_add_u32 s38, s38, 32768
    s_add_u32 s39, s39, 4096
    s_mov_b32 m0, s39
    s_nop 0
    buffer_load_dwordx4 v144, s[4:7], s38 offen offset:0 lds
    buffer_load_dwordx4 v145, s[4:7], s38 offen offset:1024 lds
    buffer_load_dwordx4 v146, s[4:7], s38 offen offset:2048 lds
    buffer_load_dwordx4 v147, s[4:7], s38 offen offset:3072 lds
    v_lshlrev_b32 v2, 10, v1
    s_and_b32 s38, s28, 7
    s_lshl_b32 s38, s38, 2
    s_add_u32 s38, s38, s30
    s_lshl_b32 s38, s38, 14
    s_lshl_b32 s39, s29, 7
    s_add_u32 s38, s38, s39
    s_mov_b64 exec, 0xffff
    buffer_load_dword v3, v2, s[8:11], s38 offen
    s_mov_b64 exec, -1
    s_lshl_b32 s38, s28, 8
    s_lshl_b32 s39, s47, 7
    s_add_u32 s38, s38, s39
    s_add_u32 s38, s38, 188416
    v_and_b32 v128, 120, v156
    v_add_u32 v128, s38, v128
    s_mov_b32 s77, 0
FP_11:
    buffer_load_dwordx2 v[130:131], v128, s[24:27], 0 offen sc1
    s_add_u32 s77, s77, 1
    s_waitcnt vmcnt(0)
    v_cmp_ne_u64 vcc, s[78:79], v[130:131]
    s_cbranch_vccz FD_12
    s_cmp_gt_u32 s77, 65536
    s_cbranch_scc1 FD_12
    s_sleep 8
    s_branch FP_11
FD_12:
    s_add_u32 s38, s43, 0
    buffer_load_dwordx4 v[64:67], v10, s[24:27], s38 offen offset:0 sc1
    buffer_load_dwordx4 v[68:71], v10, s[24:27], s38 offen offset:1024 sc1
    buffer_load_dwordx4 v[72:75], v10, s[24:27], s38 offen offset:2048 sc1
    buffer_load_dwordx4 v[76:79], v10, s[24:27], s38 offen offset:3072 sc1
    s_add_u32 s38, s43, 4096
    buffer_load_dwordx4 v[80:83], v10, s[24:27], s38 offen offset:0 sc1
    buffer_load_dwordx4 v[84:87], v10, s[24:27], s38 offen offset:1024 sc1
    buffer_load_dwordx4 v[88:91], v10, s[24:27], s38 offen offset:2048 sc1
    buffer_load_dwordx4 v[92:95], v10, s[24:27], s38 offen offset:3072 sc1
    s_add_u32 s38, s43, 8192
    buffer_load_dwordx4 v[96:99], v10, s[24:27], s38 offen offset:0 sc1
    buffer_load_dwordx4 v[100:103], v10, s[24:27], s38 offen offset:1024 sc1
    buffer_load_dwordx4 v[104:107], v10, s[24:27], s38 offen offset:2048 sc1
    buffer_load_dwordx4 v[108:111], v10, s[24:27], s38 offen offset:3072 sc1
    s_add_u32 s38, s43, 12288
    buffer_load_dwordx4 v[112:115], v10, s[24:27], s38 offen offset:0 sc1
    buffer_load_dwordx4 v[116:119], v10, s[24:27], s38 offen offset:1024 sc1
    buffer_load_dwordx4 v[120:123], v10, s[24:27], s38 offen offset:2048 sc1
    buffer_load_dwordx4 v[124:127], v10, s[24:27], s38 offen offset:3072 sc1
    s_waitcnt vmcnt(0)
    v_mov_b32 v128, 157704
    v_mov_b32 v129, 1
    s_mov_b64 exec, 1
    ds_add_u32 v128, v129
    s_mov_b64 exec, -1
    v_mov_b32 v128, 157704
    s_mov_b32 s77, 0
LW_13:
    ds_read_b32 v129, v128
    s_add_u32 s77, s77, 1
    s_waitcnt lgkmcnt(0)
    v_cmp_gt_u32 vcc, 4, v129
    s_cbranch_vccz LD_14
    s_cmp_gt_u32 s77, 524288
    s_cbranch_scc1 LD_14
    s_sleep 4
    s_branch LW_13
LD_14:
    s_or_b32 s38, s2, s30
    s_cbranch_scc1 L_noepoch
    s_mov_b32 s38, 149504
    v_mov_b32 v128, s78
    v_mov_b32 v129, s79
    v_mov_b32 v130, 0
    s_mov_b64 exec, 1
    buffer_store_dwordx2 v[128:129], v130, s[24:27], s38 offen sc1
    s_mov_b64 exec, -1
L_noepoch:
    ds_read_b64_tr_b16 v[48:49], v148 offset:0
    ds_read_b64_tr_b16 v[50:51], v148 offset:1024
    ds_read_b64_tr_b16 v[52:53], v149 offset:0
    ds_read_b64_tr_b16 v[54:55], v149 offset:1024
    ds_read_b64_tr_b16 v[56:57], v148 offset:2048
    ds_read_b64_tr_b16 v[58:59], v148 offset:3072
    ds_read_b64_tr_b16 v[60:61], v149 offset:2048
    ds_read_b64_tr_b16 v[62:63], v149 offset:3072
    s_lshl_b32 s38, s47, 14
    s_mov_b32 s38, 0x10000
    v_add_u32 v2, s38, v148
    v_add_u32 v3, s38, v149
    s_lshl_b32 s36, s44, 15
    s_lshl_b32 s39, s29, 7
    s_add_u32 s36, s36, s39
    s_lshl_b32 s39, s47, 6
    s_add_u32 s36, s36, s39
    s_lshl_b32 s36, s28, 16
    s_lshl_b32 s39, s30, 14
    s_add_u32 s36, s36, s39
    s_lshl_b32 s39, s29, 7
    s_add_u32 s36, s36, s39
    s_lshl_b32 s38, s30, 17
    s_lshl_b32 s39, s29, 7
    s_add_u32 s38, s38, s39
    s_lshl_b32 s39, s30, 14
    s_add_u32 s39, s39, 0x10000
    s_barrier
    s_mov_b32 m0, s39
    s_nop 0
    buffer_load_dwordx4 v144, s[8:11], s38 offen offset:0 lds
    ds_read_b64_tr_b16 v[132:133], v148 offset:4096
    ds_read_b64_tr_b16 v[134:135], v148 offset:5120
    ds_read_b64_tr_b16 v[136:137], v149 offset:4096
    ds_read_b64_tr_b16 v[138:139], v149 offset:5120
    s_waitcnt lgkmcnt(8)
    v_mfma_f32_32x32x16_bf16 v[16:31], v[48:51], v[64:67], 0
    v_mfma_f32_32x32x16_bf16 v[32:47], v[52:55], v[64:67], 0
    buffer_load_dwordx4 v145, s[8:11], s38 offen offset:1024 lds
    ds_read_b64_tr_b16 v[48:49], v148 offset:6144
    ds_read_b64_tr_b16 v[50:51], v148 offset:7168
    ds_read_b64_tr_b16 v[52:53], v149 offset:6144
    ds_read_b64_tr_b16 v[54:55], v149 offset:7168
    s_waitcnt lgkmcnt(8)
    v_mfma_f32_32x32x16_bf16 v[16:31], v[56:59], v[68:71], v[16:31]
    v_mfma_f32_32x32x16_bf16 v[32:47], v[60:63], v[68:71], v[32:47]
    buffer_load_dwordx4 v146, s[8:11], s38 offen offset:2048 lds
    ds_read_b64_tr_b16 v[56:57], v148 offset:8192
    ds_read_b64_tr_b16 v[58:59], v148 offset:9216
    ds_read_b64_tr_b16 v[60:61], v149 offset:8192
    ds_read_b64_tr_b16 v[62:63], v149 offset:9216
    s_waitcnt lgkmcnt(8)
    v_mfma_f32_32x32x16_bf16 v[16:31], v[132:135], v[72:75], v[16:31]
    v_mfma_f32_32x32x16_bf16 v[32:47], v[136:139], v[72:75], v[32:47]
    buffer_load_dwordx4 v147, s[8:11], s38 offen offset:3072 lds
    s_add_u32 s38, s38, 32768
    s_add_u32 s39, s39, 4096
    ds_read_b64_tr_b16 v[132:133], v148 offset:10240
    ds_read_b64_tr_b16 v[134:135], v148 offset:11264
    ds_read_b64_tr_b16 v[136:137], v149 offset:10240
    ds_read_b64_tr_b16 v[138:139], v149 offset:11264
    s_waitcnt lgkmcnt(8)
    v_mfma_f32_32x32x16_bf16 v[16:31], v[48:51], v[76:79], v[16:31]
    v_mfma_f32_32x32x16_bf16 v[32:47], v[52:55], v[76:79], v[32:47]
    s_mov_b32 m0, s39
    s_nop 0
    buffer_load_dwordx4 v144, s[8:11], s38 offen offset:0 lds
    ds_read_b64_tr_b16 v[48:49], v148 offset:12288
    ds_read_b64_tr_b16 v[50:51], v148 offset:13312
    ds_read_b64_tr_b16 v[52:53], v149 offset:12288
    ds_read_b64_tr_b16 v[54:55], v149 offset:13312
    s_waitcnt lgkmcnt(8)
    v_mfma_f32_32x32x16_bf16 v[16:31], v[56:59], v[80:83], v[16:31]
    v_mfma_f32_32x32x16_bf16 v[32:47], v[60:63], v[80:83], v[32:47]
    buffer_load_dwordx4 v145, s[8:11], s38 offen offset:1024 lds
    ds_read_b64_tr_b16 v[56:57], v148 offset:14336
    ds_read_b64_tr_b16 v[58:59], v148 offset:15360
    ds_read_b64_tr_b16 v[60:61], v149 offset:14336
    ds_read_b64_tr_b16 v[62:63], v149 offset:15360
    s_waitcnt lgkmcnt(8)
    v_mfma_f32_32x32x16_bf16 v[16:31], v[132:135], v[84:87], v[16:31]
    v_mfma_f32_32x32x16_bf16 v[32:47], v[136:139], v[84:87], v[32:47]
    buffer_load_dwordx4 v146, s[8:11], s38 offen offset:2048 lds
    ds_read_b64_tr_b16 v[132:133], v148 offset:16384
    ds_read_b64_tr_b16 v[134:135], v148 offset:17408
    ds_read_b64_tr_b16 v[136:137], v149 offset:16384
    ds_read_b64_tr_b16 v[138:139], v149 offset:17408
    s_waitcnt lgkmcnt(8)
    v_mfma_f32_32x32x16_bf16 v[16:31], v[48:51], v[88:91], v[16:31]
    v_mfma_f32_32x32x16_bf16 v[32:47], v[52:55], v[88:91], v[32:47]
    buffer_load_dwordx4 v147, s[8:11], s38 offen offset:3072 lds
    s_add_u32 s38, s38, 32768
    s_add_u32 s39, s39, 4096
    ds_read_b64_tr_b16 v[48:49], v148 offset:18432
    ds_read_b64_tr_b16 v[50:51], v148 offset:19456
    ds_read_b64_tr_b16 v[52:53], v149 offset:18432
    ds_read_b64_tr_b16 v[54:55], v149 offset:19456
    s_waitcnt lgkmcnt(8)
    v_mfma_f32_32x32x16_bf16 v[16:31], v[56:59], v[92:95], v[16:31]
    v_mfma_f32_32x32x16_bf16 v[32:47], v[60:63], v[92:95], v[32:47]
    s_mov_b32 m0, s39
    s_nop 0
    buffer_load_dwordx4 v144, s[8:11], s38 offen offset:0 lds
    ds_read_b64_tr_b16 v[56:57], v148 offset:20480
    ds_read_b64_tr_b16 v[58:59], v148 offset:21504
    ds_read_b64_tr_b16 v[60:61], v149 offset:20480
    ds_read_b64_tr_b16 v[62:63], v149 offset:21504
    s_waitcnt lgkmcnt(8)
    v_mfma_f32_32x32x16_bf16 v[16:31], v[132:135], v[96:99], v[16:31]
    v_mfma_f32_32x32x16_bf16 v[32:47], v[136:139], v[96:99], v[32:47]
    buffer_load_dwordx4 v145, s[8:11], s38 offen offset:1024 lds
    ds_read_b64_tr_b16 v[132:133], v148 offset:22528
    ds_read_b64_tr_b16 v[134:135], v148 offset:23552
    ds_read_b64_tr_b16 v[136:137], v149 offset:22528
    ds_read_b64_tr_b16 v[138:139], v149 offset:23552
    s_waitcnt lgkmcnt(8)
    v_mfma_f32_32x32x16_bf16 v[16:31], v[48:51], v[100:103], v[16:31]
    v_mfma_f32_32x32x16_bf16 v[32:47], v[52:55], v[100:103], v[32:47]
    buffer_load_dwordx4 v146, s[8:11], s38 offen offset:2048 lds
    ds_read_b64_tr_b16 v[48:49], v148 offset:24576
    ds_read_b64_tr_b16 v[50:51], v148 offset:25600
    ds_read_b64_tr_b16 v[52:53], v149 offset:24576
    ds_read_b64_tr_b16 v[54:55], v149 offset:25600
    s_waitcnt lgkmcnt(8)
    v_mfma_f32_32x32x16_bf16 v[16:31], v[56:59], v[104:107], v[16:31]
    v_mfma_f32_32x32x16_bf16 v[32:47], v[60:63], v[104:107], v[32:47]
    buffer_load_dwordx4 v147, s[8:11], s38 offen offset:3072 lds
    s_add_u32 s38, s38, 32768
    s_add_u32 s39, s39, 4096
    ds_read_b64_tr_b16 v[56:57], v148 offset:26624
    ds_read_b64_tr_b16 v[58:59], v148 offset:27648
    ds_read_b64_tr_b16 v[60:61], v149 offset:26624
    ds_read_b64_tr_b16 v[62:63], v149 offset:27648
    s_waitcnt lgkmcnt(8)
    v_mfma_f32_32x32x16_bf16 v[16:31], v[132:135], v[108:111], v[16:31]
    v_mfma_f32_32x32x16_bf16 v[32:47], v[136:139], v[108:111], v[32:47]
    s_mov_b32 m0, s39
    s_nop 0
    buffer_load_dwordx4 v144, s[8:11], s38 offen offset:0 lds
    ds_read_b64_tr_b16 v[132:133], v148 offset:28672
    ds_read_b64_tr_b16 v[134:135], v148 offset:29696
    ds_read_b64_tr_b16 v[136:137], v149 offset:28672
    ds_read_b64_tr_b16 v[138:139], v149 offset:29696
    s_waitcnt lgkmcnt(8)
    v_mfma_f32_32x32x16_bf16 v[16:31], v[48:51], v[112:115], v[16:31]
    v_mfma_f32_32x32x16_bf16 v[32:47], v[52:55], v[112:115], v[32:47]
    buffer_load_dwordx4 v145, s[8:11], s38 offen offset:1024 lds
    ds_read_b64_tr_b16 v[48:49], v148 offset:30720
    ds_read_b64_tr_b16 v[50:51], v148 offset:31744
    ds_read_b64_tr_b16 v[52:53], v149 offset:30720
    ds_read_b64_tr_b16 v[54:55], v149 offset:31744
    s_waitcnt lgkmcnt(8)
    v_mfma_f32_32x32x16_bf16 v[16:31], v[56:59], v[116:119], v[16:31]
    v_mfma_f32_32x32x16_bf16 v[32:47], v[60:63], v[116:119], v[32:47]
    buffer_load_dwordx4 v146, s[8:11], s38 offen offset:2048 lds
    s_waitcnt lgkmcnt(4)
    v_mfma_f32_32x32x16_bf16 v[16:31], v[132:135], v[120:123], v[16:31]
    v_mfma_f32_32x32x16_bf16 v[32:47], v[136:139], v[120:123], v[32:47]
    buffer_load_dwordx4 v147, s[8:11], s38 offen offset:3072 lds
    s_add_u32 s38, s38, 32768
    s_add_u32 s39, s39, 4096
    s_waitcnt lgkmcnt(0)
    v_mfma_f32_32x32x16_bf16 v[32:47], v[52:55], v[124:127], v[32:47]
    v_mfma_f32_32x32x16_bf16 v[16:31], v[48:51], v[124:127], v[16:31]
    s_mov_b32 s77, 0
    s_add_u32 s38, s43, 32768
    buffer_load_dwordx4 v[64:67], v10, s[24:27], s38 offen offset:0 sc1
    buffer_load_dwordx4 v[68:71], v10, s[24:27], s38 offen offset:1024 sc1
    buffer_load_dwordx4 v[72:75], v10, s[24:27], s38 offen offset:2048 sc1
    buffer_load_dwordx4 v[76:79], v10, s[24:27], s38 offen offset:3072 sc1
    s_add_u32 s38, s43, 36864
    buffer_load_dwordx4 v[80:83], v10, s[24:27], s38 offen offset:0 sc1
    buffer_load_dwordx4 v[84:87], v10, s[24:27], s38 offen offset:1024 sc1
    buffer_load_dwordx4 v[88:91], v10, s[24:27], s38 offen offset:2048 sc1
    buffer_load_dwordx4 v[92:95], v10, s[24:27], s38 offen offset:3072 sc1
    s_waitcnt vmcnt(8)
    s_barrier
    ds_read_b64_tr_b16 v[48:49], v2 offset:0
    ds_read_b64_tr_b16 v[50:51], v2 offset:1024
    ds_read_b64_tr_b16 v[52:53], v3 offset:0
    ds_read_b64_tr_b16 v[54:55], v3 offset:1024
    ds_read_b64_tr_b16 v[56:57], v2 offset:2048
    ds_read_b64_tr_b16 v[58:59], v2 offset:3072
    ds_read_b64_tr_b16 v[60:61], v3 offset:2048
    ds_read_b64_tr_b16 v[62:63], v3 offset:3072
    s_waitcnt vmcnt(4)
    v_max3_u32 v128, v64, v65, v66
    v_max3_u32 v129, v67, v68, v69
    v_max3_u32 v128, v128, v70, v71
    v_max3_u32 v129, v129, v72, v73
    v_max3_u32 v128, v128, v74, v75
    v_max3_u32 v129, v129, v76, v77
    v_max3_u32 v128, v128, v78, v79
    v_max_u32 v128, v128, v129
    v_cmp_eq_u32 vcc, -1, v128
    s_cbranch_vccnz L_retryB0
L_goB0:
    ds_read_b64_tr_b16 v[132:133], v2 offset:4096
    ds_read_b64_tr_b16 v[134:135], v2 offset:5120
    ds_read_b64_tr_b16 v[136:137], v3 offset:4096
    ds_read_b64_tr_b16 v[138:139], v3 offset:5120
    s_waitcnt lgkmcnt(8)
    v_mfma_f32_32x32x16_bf16 v[16:31], v[48:51], v[64:67], v[16:31]
    v_mfma_f32_32x32x16_bf16 v[32:47], v[52:55], v[64:67], v[32:47]
    s_add_u32 s38, s43, 40960
    buffer_load_dwordx4 v[96:99], v10, s[24:27], s38 offen offset:0 sc1
    buffer_load_dwordx4 v[100:103], v10, s[24:27], s38 offen offset:1024 sc1
    buffer_load_dwordx4 v[104:107], v10, s[24:27], s38 offen offset:2048 sc1
    buffer_load_dwordx4 v[108:111], v10, s[24:27], s38 offen offset:3072 sc1
    ds_read_b64_tr_b16 v[48:49], v2 offset:6144
    ds_read_b64_tr_b16 v[50:51], v2 offset:7168
    ds_read_b64_tr_b16 v[52:53], v3 offset:6144
    ds_read_b64_tr_b16 v[54:55], v3 offset:7168
    s_waitcnt lgkmcnt(8)
    v_mfma_f32_32x32x16_bf16 v[16:31], v[56:59], v[68:71], v[16:31]
    v_mfma_f32_32x32x16_bf16 v[32:47], v[60:63], v[68:71], v[32:47]
    ds_read_b64_tr_b16 v[56:57], v2 offset:8192
    ds_read_b64_tr_b16 v[58:59], v2 offset:9216
    ds_read_b64_tr_b16 v[60:61], v3 offset:8192
    ds_read_b64_tr_b16 v[62:63], v3 offset:9216
    s_waitcnt lgkmcnt(8)
    v_mfma_f32_32x32x16_bf16 v[16:31], v[132:135], v[72:75], v[16:31]
    v_mfma_f32_32x32x16_bf16 v[32:47], v[136:139], v[72:75], v[32:47]
    ds_read_b64_tr_b16 v[132:133], v2 offset:10240
    ds_read_b64_tr_b16 v[134:135], v2 offset:11264
    ds_read_b64_tr_b16 v[136:137], v3 offset:10240
    ds_read_b64_tr_b16 v[138:139], v3 offset:11264
    s_waitcnt lgkmcnt(8)
    v_mfma_f32_32x32x16_bf16 v[16:31], v[48:51], v[76:79], v[16:31]
    s_waitcnt vmcnt(4)
    v_max3_u32 v128, v80, v81, v82
    v_max3_u32 v129, v83, v84, v85
    v_max3_u32 v128, v128, v86, v87
    v_max3_u32 v129, v129, v88, v89
    v_mfma_f32_32x32x16_bf16 v[32:47], v[52:55], v[76:79], v[32:47]
    v_max3_u32 v128, v128, v90, v91
    v_max3_u32 v129, v129, v92, v93
    v_max3_u32 v128, v128, v94, v95
    v_max_u32 v128, v128, v129
    v_cmp_eq_u32 vcc, -1, v128
    s_cbranch_vccnz L_retryB1
L_goB1:
    ds_read_b64_tr_b16 v[48:49], v2 offset:12288
    ds_read_b64_tr_b16 v[50:51], v2 offset:13312
    ds_read_b64_tr_b16 v[52:53], v3 offset:12288
    ds_read_b64_tr_b16 v[54:55], v3 offset:13312
    s_waitcnt lgkmcnt(8)
    v_mfma_f32_32x32x16_bf16 v[16:31], v[56:59], v[80:83], v[16:31]
    v_mfma_f32_32x32x16_bf16 v[32:47], v[60:63], v[80:83], v[32:47]
    s_add_u32 s38, s43, 45056
    buffer_load_dwordx4 v[112:115], v10, s[24:27], s38 offen offset:0 sc1
    buffer_load_dwordx4 v[116:119], v10, s[24:27], s38 offen offset:1024 sc1
    buffer_load_dwordx4 v[120:123], v10, s[24:27], s38 offen offset:2048 sc1
    buffer_load_dwordx4 v[124:127], v10, s[24:27], s38 offen offset:3072 sc1
    ds_read_b64_tr_b16 v[56:57], v2 offset:14336
    ds_read_b64_tr_b16 v[58:59], v2 offset:15360
    ds_read_b64_tr_b16 v[60:61], v3 offset:14336
    ds_read_b64_tr_b16 v[62:63], v3 offset:15360
    s_waitcnt lgkmcnt(8)
    v_mfma_f32_32x32x16_bf16 v[16:31], v[132:135], v[84:87], v[16:31]
    v_mfma_f32_32x32x16_bf16 v[32:47], v[136:139], v[84:87], v[32:47]
    ds_read_b64_tr_b16 v[132:133], v2 offset:16384
    ds_read_b64_tr_b16 v[134:135], v2 offset:17408
    ds_read_b64_tr_b16 v[136:137], v3 offset:16384
    ds_read_b64_tr_b16 v[138:139], v3 offset:17408
    s_waitcnt lgkmcnt(8)
    v_mfma_f32_32x32x16_bf16 v[16:31], v[48:51], v[88:91], v[16:31]
    v_mfma_f32_32x32x16_bf16 v[32:47], v[52:55], v[88:91], v[32:47]
    ds_read_b64_tr_b16 v[48:49], v2 offset:18432
    ds_read_b64_tr_b16 v[50:51], v2 offset:19456
    ds_read_b64_tr_b16 v[52:53], v3 offset:18432
    ds_read_b64_tr_b16 v[54:55], v3 offset:19456
    s_waitcnt lgkmcnt(8)
    v_mfma_f32_32x32x16_bf16 v[16:31], v[56:59], v[92:95], v[16:31]
    s_waitcnt vmcnt(4)
    v_max3_u32 v128, v96, v97, v98
    v_max3_u32 v129, v99, v100, v101
    v_max3_u32 v128, v128, v102, v103
    v_max3_u32 v129, v129, v104, v105
    v_mfma_f32_32x32x16_bf16 v[32:47], v[60:63], v[92:95], v[32:47]
    v_max3_u32 v128, v128, v106, v107
    v_max3_u32 v129, v129, v108, v109
    v_max3_u32 v128, v128, v110, v111
    v_max_u32 v128, v128, v129
    v_cmp_eq_u32 vcc, -1, v128
    s_cbranch_vccnz L_retryB2
L_goB2:
    ds_read_b64_tr_b16 v[56:57], v2 offset:20480
    ds_read_b64_tr_b16 v[58:59], v2 offset:21504
    ds_read_b64_tr_b16 v[60:61], v3 offset:20480
    ds_read_b64_tr_b16 v[62:63], v3 offset:21504
    s_waitcnt lgkmcnt(8)
    v_mfma_f32_32x32x16_bf16 v[16:31], v[132:135], v[96:99], v[16:31]
    v_mfma_f32_32x32x16_bf16 v[32:47], v[136:139], v[96:99], v[32:47]
    ds_read_b64_tr_b16 v[132:133], v2 offset:22528
    ds_read_b64_tr_b16 v[134:135], v2 offset:23552
    ds_read_b64_tr_b16 v[136:137], v3 offset:22528
    ds_read_b64_tr_b16 v[138:139], v3 offset:23552
    s_waitcnt lgkmcnt(8)
    v_mfma_f32_32x32x16_bf16 v[16:31], v[48:51], v[100:103], v[16:31]
    v_mfma_f32_32x32x16_bf16 v[32:47], v[52:55], v[100:103], v[32:47]
    ds_read_b64_tr_b16 v[48:49], v2 offset:24576
    ds_read_b64_tr_b16 v[50:51], v2 offset:25600
    ds_read_b64_tr_b16 v[52:53], v3 offset:24576
    ds_read_b64_tr_b16 v[54:55], v3 offset:25600
    s_waitcnt lgkmcnt(8)
    v_mfma_f32_32x32x16_bf16 v[16:31], v[56:59], v[104:107], v[16:31]
    v_mfma_f32_32x32x16_bf16 v[32:47], v[60:63], v[104:107], v[32:47]
    ds_read_b64_tr_b16 v[56:57], v2 offset:26624
    ds_read_b64_tr_b16 v[58:59], v2 offset:27648
    ds_read_b64_tr_b16 v[60:61], v3 offset:26624
    ds_read_b64_tr_b16 v[62:63], v3 offset:27648
    s_waitcnt lgkmcnt(8)
    v_mfma_f32_32x32x16_bf16 v[16:31], v[132:135], v[108:111], v[16:31]
    s_waitcnt vmcnt(0)
    v_max3_u32 v128, v112, v113, v114
    v_max3_u32 v129, v115, v116, v117
    v_max3_u32 v128, v128, v118, v119
    v_max3_u32 v129, v129, v120, v121
    v_mfma_f32_32x32x16_bf16 v[32:47], v[136:139], v[108:111], v[32:47]
    v_max3_u32 v128, v128, v122, v123
    v_max3_u32 v129, v129, v124, v125
    v_max3_u32 v128, v128, v126, v127
    v_max_u32 v128, v128, v129
    v_cmp_eq_u32 vcc, -1, v128
    s_cbranch_vccnz L_retryB3
L_goB3:
    ds_read_b64_tr_b16 v[132:133], v2 offset:28672
    ds_read_b64_tr_b16 v[134:135], v2 offset:29696
    ds_read_b64_tr_b16 v[136:137], v3 offset:28672
    ds_read_b64_tr_b16 v[138:139], v3 offset:29696
    s_waitcnt lgkmcnt(8)
    v_mfma_f32_32x32x16_bf16 v[16:31], v[48:51], v[112:115], v[16:31]
    v_mfma_f32_32x32x16_bf16 v[32:47], v[52:55], v[112:115], v[32:47]
    ds_read_b64_tr_b16 v[48:49], v2 offset:30720
    ds_read_b64_tr_b16 v[50:51], v2 offset:31744
    ds_read_b64_tr_b16 v[52:53], v3 offset:30720
    ds_read_b64_tr_b16 v[54:55], v3 offset:31744
    s_waitcnt lgkmcnt(8)
    v_mfma_f32_32x32x16_bf16 v[16:31], v[56:59], v[116:119], v[16:31]
    v_mfma_f32_32x32x16_bf16 v[32:47], v[60:63], v[116:119], v[32:47]
    s_waitcnt lgkmcnt(4)
    v_mfma_f32_32x32x16_bf16 v[16:31], v[132:135], v[120:123], v[16:31]
    v_mfma_f32_32x32x16_bf16 v[32:47], v[136:139], v[120:123], v[32:47]
    s_waitcnt lgkmcnt(0)
    v_mfma_f32_32x32x16_bf16 v[32:47], v[52:55], v[124:127], v[32:47]
    v_mfma_f32_32x32x16_bf16 v[16:31], v[48:51], v[124:127], v[16:31]
    s_nop 10
    ds_write_b128 v151, v[32:35] offset:0
    ds_write_b128 v151, v[36:39] offset:32
    ds_write_b128 v151, v[40:43] offset:64
    ds_write_b128 v151, v[44:47] offset:96
    ds_write_b128 v150, v[16:19] offset:0
    ds_write_b128 v150, v[20:23] offset:32
    ds_write_b128 v150, v[24:27] offset:64
    ds_write_b128 v150, v[28:31] offset:96
    s_waitcnt lgkmcnt(0)
    s_barrier
    ds_read_b128 v[64:67], v157 offset:0
    ds_read_b128 v[68:71], v157 offset:16
    ds_read_b128 v[72:75], v157 offset:17408
    ds_read_b128 v[76:79], v157 offset:17424
    ds_read_b128 v[80:83], v157 offset:2176
    ds_read_b128 v[84:87], v157 offset:2192
    ds_read_b128 v[88:91], v157 offset:19584
    ds_read_b128 v[92:95], v157 offset:19600
    s_waitcnt lgkmcnt(4)
    v_pk_add_f32 v[64:65], v[64:65], v[72:73]
    v_pk_add_f32 v[66:67], v[66:67], v[74:75]
    v_pk_add_f32 v[68:69], v[68:69], v[76:77]
    v_pk_add_f32 v[70:71], v[70:71], v[78:79]
    v_cvt_pk_bf16_f32 v64, v64, v65
    v_cvt_pk_bf16_f32 v65, v66, v67
    v_cvt_pk_bf16_f32 v66, v68, v69
    v_cvt_pk_bf16_f32 v67, v70, v71
    buffer_store_dwordx4 v[64:67], v152, s[12:15], s36 offen
    s_add_u32 s36, s36, 8192
    s_waitcnt lgkmcnt(0)
    v_pk_add_f32 v[80:81], v[80:81], v[88:89]
    v_pk_add_f32 v[82:83], v[82:83], v[90:91]
    v_pk_add_f32 v[84:85], v[84:85], v[92:93]
    v_pk_add_f32 v[86:87], v[86:87], v[94:95]
    v_cvt_pk_bf16_f32 v80, v80, v81
    v_cvt_pk_bf16_f32 v81, v82, v83
    v_cvt_pk_bf16_f32 v82, v84, v85
    v_cvt_pk_bf16_f32 v83, v86, v87
    buffer_store_dwordx4 v[80:83], v152, s[12:15], s36 offen
L_done:
    s_endpgm
L_retryB0:
    s_add_u32 s38, s43, 32768
    buffer_load_dwordx4 v[64:67], v10, s[24:27], s38 offen offset:0 sc1
    buffer_load_dwordx4 v[68:71], v10, s[24:27], s38 offen offset:1024 sc1
    buffer_load_dwordx4 v[72:75], v10, s[24:27], s38 offen offset:2048 sc1
    buffer_load_dwordx4 v[76:79], v10, s[24:27], s38 offen offset:3072 sc1
    s_add_u32 s38, s43, 36864
    buffer_load_dwordx4 v[80:83], v10, s[24:27], s38 offen offset:0 sc1
    buffer_load_dwordx4 v[84:87], v10, s[24:27], s38 offen offset:1024 sc1
    buffer_load_dwordx4 v[88:91], v10, s[24:27], s38 offen offset:2048 sc1
    buffer_load_dwordx4 v[92:95], v10, s[24:27], s38 offen offset:3072 sc1
    s_add_u32 s77, s77, 1
    s_waitcnt vmcnt(4)
    v_max3_u32 v128, v64, v65, v66
    v_max3_u32 v129, v67, v68, v69
    v_max3_u32 v128, v128, v70, v71
    v_max3_u32 v129, v129, v72, v73
    v_max3_u32 v128, v128, v74, v75
    v_max3_u32 v129, v129, v76, v77
    v_max3_u32 v128, v128, v78, v79
    v_max_u32 v128, v128, v129
    v_cmp_eq_u32 vcc, -1, v128
    s_cbranch_vccz L_goB0
    s_cmp_lt_u32 s77, 65536
    s_cbranch_scc1 L_retryB0
    s_branch L_goB0
L_retryB1:
    s_add_u32 s38, s43, 36864
    buffer_load_dwordx4 v[80:83], v10, s[24:27], s38 offen offset:0 sc1
    buffer_load_dwordx4 v[84:87], v10, s[24:27], s38 offen offset:1024 sc1
    buffer_load_dwordx4 v[88:91], v10, s[24:27], s38 offen offset:2048 sc1
    buffer_load_dwordx4 v[92:95], v10, s[24:27], s38 offen offset:3072 sc1
    s_add_u32 s38, s43, 40960
    buffer_load_dwordx4 v[96:99], v10, s[24:27], s38 offen offset:0 sc1
    buffer_load_dwordx4 v[100:103], v10, s[24:27], s38 offen offset:1024 sc1
    buffer_load_dwordx4 v[104:107], v10, s[24:27], s38 offen offset:2048 sc1
    buffer_load_dwordx4 v[108:111], v10, s[24:27], s38 offen offset:3072 sc1
    s_add_u32 s77, s77, 1
    s_waitcnt vmcnt(4)
    v_max3_u32 v128, v80, v81, v82
    v_max3_u32 v129, v83, v84, v85
    v_max3_u32 v128, v128, v86, v87
    v_max3_u32 v129, v129, v88, v89
    v_max3_u32 v128, v128, v90, v91
    v_max3_u32 v129, v129, v92, v93
    v_max3_u32 v128, v128, v94, v95
    v_max_u32 v128, v128, v129
    v_cmp_eq_u32 vcc, -1, v128
    s_cbranch_vccz L_goB1
    s_cmp_lt_u32 s77, 65536
    s_cbranch_scc1 L_retryB1
    s_branch L_goB1
L_retryB2:
    s_add_u32 s38, s43, 40960
    buffer_load_dwordx4 v[96:99], v10, s[24:27], s38 offen offset:0 sc1
    buffer_load_dwordx4 v[100:103], v10, s[24:27], s38 offen offset:1024 sc1
    buffer_load_dwordx4 v[104:107], v10, s[24:27], s38 offen offset:2048 sc1
    buffer_load_dwordx4 v[108:111], v10, s[24:27], s38 offen offset:3072 sc1
    s_add_u32 s38, s43, 45056
    buffer_load_dwordx4 v[112:115], v10, s[24:27], s38 offen offset:0 sc1
    buffer_load_dwordx4 v[116:119], v10, s[24:27], s38 offen offset:1024 sc1
    buffer_load_dwordx4 v[120:123], v10, s[24:27], s38 offen offset:2048 sc1
    buffer_load_dwordx4 v[124:127], v10, s[24:27], s38 offen offset:3072 sc1
    s_add_u32 s77, s77, 1
    s_waitcnt vmcnt(4)
    v_max3_u32 v128, v96, v97, v98
    v_max3_u32 v129, v99, v100, v101
    v_max3_u32 v128, v128, v102, v103
    v_max3_u32 v129, v129, v104, v105
    v_max3_u32 v128, v128, v106, v107
    v_max3_u32 v129, v129, v108, v109
    v_max3_u32 v128, v128, v110, v111
    v_max_u32 v128, v128, v129
    v_cmp_eq_u32 vcc, -1, v128
    s_cbranch_vccz L_goB2
    s_cmp_lt_u32 s77, 65536
    s_cbranch_scc1 L_retryB2
    s_branch L_goB2
L_retryB3:
    s_add_u32 s38, s43, 45056
    buffer_load_dwordx4 v[112:115], v10, s[24:27], s38 offen offset:0 sc1
    buffer_load_dwordx4 v[116:119], v10, s[24:27], s38 offen offset:1024 sc1
    buffer_load_dwordx4 v[120:123], v10, s[24:27], s38 offen offset:2048 sc1
    buffer_load_dwordx4 v[124:127], v10, s[24:27], s38 offen offset:3072 sc1
    s_add_u32 s77, s77, 1
    s_waitcnt vmcnt(0)
    v_max3_u32 v128, v112, v113, v114
    v_max3_u32 v129, v115, v116, v117
    v_max3_u32 v128, v128, v118, v119
    v_max3_u32 v129, v129, v120, v121
    v_max3_u32 v128, v128, v122, v123
    v_max3_u32 v129, v129, v124, v125
    v_max3_u32 v128, v128, v126, v127
    v_max_u32 v128, v128, v129
    v_cmp_eq_u32 vcc, -1, v128
    s_cbranch_vccz L_goB3
    s_cmp_lt_u32 s77, 65536
    s_cbranch_scc1 L_retryB3
    s_branch L_goB3
L_compute:
    s_and_b32 s44, s30, 3
    s_lshr_b32 s40, s30, 2
    v_and_b32 v11, 31, v1
    v_lshrrev_b32 v22, 5, v1
    v_bfe_u32 v23, v1, 1, 3
    v_xor_b32 v23, v23, v22
    v_lshlrev_b32 v23, 4, v23
    v_lshl_add_u32 v12, v11, 7, v23
    v_add_u32 v12, 65536, v12
    v_xor_b32 v13, 32, v12
    v_xor_b32 v14, 64, v12
    v_xor_b32 v15, 96, v12
    s_cmp_lg_u32 s40, 0
    s_cbranch_scc1 L_qwave
    v_mov_b32 v26, 157696
    v_mov_b32 v32, 0
    v_mov_b32 v33, 0
    v_mov_b32 v34, 0
    v_mov_b32 v35, 0
    ds_write_b128 v26, v[32:35]
    ds_write_b128 v26, v[32:35] offset:16
    v_lshrrev_b32 v22, 5, v1
    v_bfe_u32 v23, v1, 2, 2
    v_lshl_add_u32 v20, v22, 3, v23
    v_lshlrev_b32 v20, 7, v20
    v_bfe_u32 v23, v1, 3, 2
    v_xor_b32 v23, s44, v23
    v_lshl_add_u32 v20, v23, 5, v20
    v_bfe_u32 v24, v1, 4, 1
    v_lshl_add_u32 v20, v24, 13, v20
    v_and_b32 v23, 3, v1
    v_lshl_add_u32 v20, v23, 3, v20
    s_waitcnt lgkmcnt(0)
    s_load_dwordx2 s[78:79], s[72:73], 0x24800
    s_mov_b32 s24, s72
    s_mov_b32 s25, s73
    s_mov_b32 s26, 0xb00000
    s_mov_b32 s27, 0x00020000
    s_barrier
    s_lshl_b32 s45, s29, 2
    s_add_u32 s45, s45, s44
    s_lshl_b32 s47, s28, 1
    s_xor_b32 s46, s40, 1
    s_add_u32 s47, s47, s46
    s_lshl_b32 s43, s47, 6
    s_add_u32 s43, s43, s45
    s_lshl_b32 s43, s43, 10
    s_add_u32 s43, s43, 5275648
    s_mov_b32 s74, 0x3fb8aa3b
    s_mov_b32 s75, 0xbfb8aa3b
    s_mov_b32 s76, 0x3eb8aa3b
    s_lshl_b32 s38, s44, 10
    s_add_u32 s38, s38, 147456
    v_add_u32 v28, s38, v10
    v_and_b32 v23, 15, v1
    v_lshlrev_b32 v23, 3, v23
    v_lshrrev_b32 v22, 5, v1
    v_lshl_add_u32 v25, v22, 7, v23
    s_lshl_b32 s38, s44, 9
    s_add_u32 s38, s38, 155648
    v_add_u32 v25, s38, v25
    s_barrier
    v_and_b32 v11, 31, v1
    v_lshrrev_b32 v22, 5, v1
    v_lshlrev_b32 v22, 2, v22
    v_sub_u32 v11, v11, v22
    v_mov_b32 v22, 0x3f80
    v_mov_b32 v23, 0x3f800000
    v_cmp_eq_u32 vcc, 0, v11
    v_cmp_eq_u32 s[38:39], 1, v11
    s_nop 0
    v_cndmask_b32 v148, 0, v22, vcc
    v_cndmask_b32 v148, v148, v23, s[38:39]
    v_cmp_eq_u32 vcc, 2, v11
    v_cmp_eq_u32 s[38:39], 3, v11
    s_nop 0
    v_cndmask_b32 v149, 0, v22, vcc
    v_cndmask_b32 v149, v149, v23, s[38:39]
    v_cmp_eq_u32 vcc, 8, v11
    v_cmp_eq_u32 s[38:39], 9, v11
    s_nop 0
    v_cndmask_b32 v150, 0, v22, vcc
    v_cndmask_b32 v150, v150, v23, s[38:39]
    v_cmp_eq_u32 vcc, 10, v11
    v_cmp_eq_u32 s[38:39], 11, v11
    s_nop 0
    v_cndmask_b32 v151, 0, v22, vcc
    v_cndmask_b32 v151, v151, v23, s[38:39]
    s_barrier
    v_cmp_eq_u32 vcc, 16, v11
    v_cmp_eq_u32 s[38:39], 17, v11
    s_nop 0
    v_cndmask_b32 v152, 0, v22, vcc
    v_cndmask_b32 v152, v152, v23, s[38:39]
    v_cmp_eq_u32 vcc, 18, v11
    v_cmp_eq_u32 s[38:39], 19, v11
    s_nop 0
    v_cndmask_b32 v153, 0, v22, vcc
    v_cndmask_b32 v153, v153, v23, s[38:39]
    v_cmp_eq_u32 vcc, 24, v11
    v_cmp_eq_u32 s[38:39], 25, v11
    s_nop 0
    v_cndmask_b32 v154, 0, v22, vcc
    v_cndmask_b32 v154, v154, v23, s[38:39]
    v_cmp_eq_u32 vcc, 26, v11
    v_cmp_eq_u32 s[38:39], 27, v11
    s_nop 0
    v_cndmask_b32 v155, 0, v22, vcc
    v_cndmask_b32 v155, v155, v23, s[38:39]
    v_bfe_u32 v24, v1, 4, 1
    v_mul_u32_u24 v156, 0x3f80, v24
    v_lshl_or_b32 v156, v156, 16, v156
    s_barrier
    s_waitcnt lgkmcnt(0)
    s_add_u32 s78, s78, 1
    s_barrier
    ds_read_b128 v[32:35], v12 offset:0
    ds_read_b64_tr_b16 v[40:41], v20 offset:16384
    ds_read_b64_tr_b16 v[42:43], v20 offset:16896
    ds_read_b128 v[36:39], v12 offset:4096
    ds_read_b128 v[44:47], v13 offset:0
    ds_read_b64_tr_b16 v[52:53], v20 offset:18432
    ds_read_b64_tr_b16 v[54:55], v20 offset:18944
    ds_read_b128 v[48:51], v13 offset:4096
    ds_read_b128 v[56:59], v14 offset:0
    ds_read_b64_tr_b16 v[64:65], v20 offset:20480
    ds_read_b64_tr_b16 v[66:67], v20 offset:20992
    ds_read_b128 v[60:63], v14 offset:4096
    ds_read_b128 v[68:71], v15 offset:0
    ds_read_b64_tr_b16 v[76:77], v20 offset:22528
    ds_read_b64_tr_b16 v[78:79], v20 offset:23040
    ds_read_b128 v[72:75], v15 offset:4096
    s_waitcnt lgkmcnt(0)
    s_barrier
    v_mfma_f32_32x32x16_bf16 v[96:111], v[40:43], v[32:35], 0
    ds_read_b128 v[80:83], v12 offset:8192
    ds_read_b64_tr_b16 v[88:89], v20 offset:32768
    ds_read_b64_tr_b16 v[90:91], v20 offset:33280
    ds_read_b128 v[84:87], v12 offset:12288
    v_mfma_f32_32x32x16_bf16 v[112:127], v[40:43], v[36:39], 0
    ds_read_b128 v[128:131], v13 offset:8192
    ds_read_b64_tr_b16 v[136:137], v20 offset:34816
    ds_read_b64_tr_b16 v[138:139], v20 offset:35328
    v_mfma_f32_32x32x16_bf16 v[96:111], v[52:55], v[44:47], v[96:111]
    ds_read_b128 v[132:135], v13 offset:12288
    ds_read_b128 v[92:95], v14 offset:8192
    ds_read_b64_tr_b16 v[16:17], v20 offset:36864
    v_mfma_f32_32x32x16_bf16 v[112:127], v[52:55], v[48:51], v[112:127]
    ds_read_b64_tr_b16 v[18:19], v20 offset:37376
    ds_read_b128 v[140:143], v14 offset:12288
    ds_read_b128 v[4:7], v15 offset:8192
    v_mfma_f32_32x32x16_bf16 v[96:111], v[64:67], v[56:59], v[96:111]
    ds_read_b64_tr_b16 v[164:165], v20 offset:38912
    ds_read_b64_tr_b16 v[166:167], v20 offset:39424
    ds_read_b128 v[160:163], v15 offset:12288
    v_mfma_f32_32x32x16_bf16 v[112:127], v[64:67], v[60:63], v[112:127]
    v_mfma_f32_32x32x16_bf16 v[96:111], v[76:79], v[68:71], v[96:111]
    v_mfma_f32_32x32x16_bf16 v[112:127], v[76:79], v[72:75], v[112:127]
    s_waitcnt lgkmcnt(0)
    s_barrier
    v_mfma_f32_32x32x16_bf16 v[96:111], v[88:91], v[80:83], v[96:111]
    ds_read_b128 v[32:35], v12 offset:16384
    ds_read_b64_tr_b16 v[40:41], v20 offset:49152
    ds_read_b64_tr_b16 v[42:43], v20 offset:49664
    ds_read_b128 v[36:39], v12 offset:20480
    v_mfma_f32_32x32x16_bf16 v[112:127], v[88:91], v[84:87], v[112:127]
    ds_read_b128 v[44:47], v13 offset:16384
    ds_read_b64_tr_b16 v[52:53], v20 offset:51200
    ds_read_b64_tr_b16 v[54:55], v20 offset:51712
    v_mfma_f32_32x32x16_bf16 v[96:111], v[136:139], v[128:131], v[96:111]
    ds_read_b128 v[48:51], v13 offset:20480
    ds_read_b128 v[56:59], v14 offset:16384
    ds_read_b64_tr_b16 v[64:65], v20 offset:53248
    v_mfma_f32_32x32x16_bf16 v[112:127], v[136:139], v[132:135], v[112:127]
    ds_read_b64_tr_b16 v[66:67], v20 offset:53760
    ds_read_b128 v[60:63], v14 offset:20480
    ds_read_b128 v[68:71], v15 offset:16384
    v_mfma_f32_32x32x16_bf16 v[96:111], v[16:19], v[92:95], v[96:111]
    ds_read_b64_tr_b16 v[76:77], v20 offset:55296
    ds_read_b64_tr_b16 v[78:79], v20 offset:55808
    ds_read_b128 v[72:75], v15 offset:20480
    v_mfma_f32_32x32x16_bf16 v[112:127], v[16:19], v[140:143], v[112:127]
    v_mfma_f32_32x32x16_bf16 v[96:111], v[164:167], v[4:7], v[96:111]
    v_mfma_f32_32x32x16_bf16 v[112:127], v[164:167], v[160:163], v[112:127]
    s_waitcnt lgkmcnt(0)
    s_barrier
    v_mfma_f32_32x32x16_bf16 v[96:111], v[40:43], v[32:35], v[96:111]
    ds_read_b128 v[80:83], v12 offset:24576
    ds_read_b64_tr_b16 v[88:89], v20 offset:0
    ds_read_b64_tr_b16 v[90:91], v20 offset:512
    ds_read_b128 v[84:87], v12 offset:28672
    v_mfma_f32_32x32x16_bf16 v[112:127], v[40:43], v[36:39], v[112:127]
    ds_read_b128 v[128:131], v13 offset:24576
    ds_read_b64_tr_b16 v[136:137], v20 offset:2048
    ds_read_b64_tr_b16 v[138:139], v20 offset:2560
    v_mfma_f32_32x32x16_bf16 v[96:111], v[52:55], v[44:47], v[96:111]
    ds_read_b128 v[132:135], v13 offset:28672
    ds_read_b128 v[92:95], v14 offset:24576
    ds_read_b64_tr_b16 v[16:17], v20 offset:4096
    v_mfma_f32_32x32x16_bf16 v[112:127], v[52:55], v[48:51], v[112:127]
    ds_read_b64_tr_b16 v[18:19], v20 offset:4608
    ds_read_b128 v[140:143], v14 offset:28672
    ds_read_b128 v[4:7], v15 offset:24576
    v_mfma_f32_32x32x16_bf16 v[96:111], v[64:67], v[56:59], v[96:111]
    ds_read_b64_tr_b16 v[164:165], v20 offset:6144
    ds_read_b64_tr_b16 v[166:167], v20 offset:6656
    ds_read_b128 v[160:163], v15 offset:28672
    v_mfma_f32_32x32x16_bf16 v[112:127], v[64:67], v[60:63], v[112:127]
    v_mfma_f32_32x32x16_bf16 v[96:111], v[76:79], v[68:71], v[96:111]
    v_mfma_f32_32x32x16_bf16 v[112:127], v[76:79], v[72:75], v[112:127]
    s_waitcnt lgkmcnt(0)
    s_barrier
    v_mfma_f32_32x32x16_bf16 v[96:111], v[88:91], v[80:83], v[96:111]
    ds_read_b128 v[32:35], v12 offset:32768
    ds_read_b64_tr_b16 v[40:41], v20 offset:16384
    ds_read_b64_tr_b16 v[42:43], v20 offset:16896
    ds_read_b128 v[36:39], v12 offset:36864
    v_mfma_f32_32x32x16_bf16 v[112:127], v[88:91], v[84:87], v[112:127]
    ds_read_b128 v[44:47], v13 offset:32768
    ds_read_b64_tr_b16 v[52:53], v20 offset:18432
    ds_read_b64_tr_b16 v[54:55], v20 offset:18944
    v_mfma_f32_32x32x16_bf16 v[96:111], v[136:139], v[128:131], v[96:111]
    ds_read_b128 v[48:51], v13 offset:36864
    ds_read_b128 v[56:59], v14 offset:32768
    ds_read_b64_tr_b16 v[64:65], v20 offset:20480
    v_mfma_f32_32x32x16_bf16 v[112:127], v[136:139], v[132:135], v[112:127]
    ds_read_b64_tr_b16 v[66:67], v20 offset:20992
    ds_read_b128 v[60:63], v14 offset:36864
    ds_read_b128 v[68:71], v15 offset:32768
    v_mfma_f32_32x32x16_bf16 v[96:111], v[16:19], v[92:95], v[96:111]
    ds_read_b64_tr_b16 v[76:77], v20 offset:22528
    ds_read_b64_tr_b16 v[78:79], v20 offset:23040
    ds_read_b128 v[72:75], v15 offset:36864
    v_mfma_f32_32x32x16_bf16 v[112:127], v[16:19], v[140:143], v[112:127]
    v_mfma_f32_32x32x16_bf16 v[96:111], v[164:167], v[4:7], v[96:111]
    v_mfma_f32_32x32x16_bf16 v[112:127], v[164:167], v[160:163], v[112:127]
    s_waitcnt lgkmcnt(0)
    s_barrier
    v_mfma_f32_32x32x16_bf16 v[96:111], v[40:43], v[32:35], v[96:111]
    ds_read_b128 v[80:83], v12 offset:40960
    ds_read_b64_tr_b16 v[88:89], v20 offset:32768
    ds_read_b64_tr_b16 v[90:91], v20 offset:33280
    ds_read_b128 v[84:87], v12 offset:45056
    v_mfma_f32_32x32x16_bf16 v[112:127], v[40:43], v[36:39], v[112:127]
    ds_read_b128 v[128:131], v13 offset:40960
    ds_read_b64_tr_b16 v[136:137], v20 offset:34816
    ds_read_b64_tr_b16 v[138:139], v20 offset:35328
    v_mfma_f32_32x32x16_bf16 v[96:111], v[52:55], v[44:47], v[96:111]
    ds_read_b128 v[132:135], v13 offset:45056
    ds_read_b128 v[92:95], v14 offset:40960
    ds_read_b64_tr_b16 v[16:17], v20 offset:36864
    v_mfma_f32_32x32x16_bf16 v[112:127], v[52:55], v[48:51], v[112:127]
    ds_read_b64_tr_b16 v[18:19], v20 offset:37376
    ds_read_b128 v[140:143], v14 offset:45056
    ds_read_b128 v[4:7], v15 offset:40960
    v_mfma_f32_32x32x16_bf16 v[96:111], v[64:67], v[56:59], v[96:111]
    ds_read_b64_tr_b16 v[164:165], v20 offset:38912
    ds_read_b64_tr_b16 v[166:167], v20 offset:39424
    ds_read_b128 v[160:163], v15 offset:45056
    v_mfma_f32_32x32x16_bf16 v[112:127], v[64:67], v[60:63], v[112:127]
    v_mfma_f32_32x32x16_bf16 v[96:111], v[76:79], v[68:71], v[96:111]
    v_mfma_f32_32x32x16_bf16 v[112:127], v[76:79], v[72:75], v[112:127]
    ds_read_b64_tr_b16 v[144:145], v25 offset:0
    ds_read_b64_tr_b16 v[146:147], v25 offset:256
    s_waitcnt lgkmcnt(0)
    s_barrier
    v_mfma_f32_32x32x16_bf16 v[96:111], v[88:91], v[80:83], v[96:111]
    ds_read_b128 v[32:35], v12 offset:49152
    ds_read_b64_tr_b16 v[40:41], v20 offset:49152
    ds_read_b64_tr_b16 v[42:43], v20 offset:49664
    ds_read_b128 v[36:39], v12 offset:53248
    v_mfma_f32_32x32x16_bf16 v[112:127], v[88:91], v[84:87], v[112:127]
    ds_read_b128 v[44:47], v13 offset:49152
    ds_read_b64_tr_b16 v[52:53], v20 offset:51200
    ds_read_b64_tr_b16 v[54:55], v20 offset:51712
    v_mfma_f32_32x32x16_bf16 v[96:111], v[136:139], v[128:131], v[96:111]
    ds_read_b128 v[48:51], v13 offset:53248
    ds_read_b128 v[56:59], v14 offset:49152
    ds_read_b64_tr_b16 v[64:65], v20 offset:53248
    v_mfma_f32_32x32x16_bf16 v[112:127], v[136:139], v[132:135], v[112:127]
    ds_read_b64_tr_b16 v[66:67], v20 offset:53760
    ds_read_b128 v[60:63], v14 offset:53248
    ds_read_b128 v[68:71], v15 offset:49152
    v_mfma_f32_32x32x16_bf16 v[96:111], v[16:19], v[92:95], v[96:111]
    ds_read_b64_tr_b16 v[76:77], v20 offset:55296
    ds_read_b64_tr_b16 v[78:79], v20 offset:55808
    ds_read_b128 v[72:75], v15 offset:53248
    v_mfma_f32_32x32x16_bf16 v[112:127], v[16:19], v[140:143], v[112:127]
    v_mfma_f32_32x32x16_bf16 v[96:111], v[164:167], v[4:7], v[96:111]
    v_mfma_f32_32x32x16_bf16 v[112:127], v[164:167], v[160:163], v[112:127]
    s_waitcnt lgkmcnt(0)
    s_barrier
    v_mfma_f32_32x32x16_bf16 v[96:111], v[40:43], v[32:35], v[96:111]
    ds_read_b128 v[80:83], v12 offset:57344
    ds_read_b64_tr_b16 v[88:89], v20 offset:0
    ds_read_b64_tr_b16 v[90:91], v20 offset:512
    ds_read_b128 v[84:87], v12 offset:61440
    v_mfma_f32_32x32x16_bf16 v[112:127], v[40:43], v[36:39], v[112:127]
    ds_read_b128 v[128:131], v13 offset:57344
    ds_read_b64_tr_b16 v[136:137], v20 offset:2048
    ds_read_b64_tr_b16 v[138:139], v20 offset:2560
    v_mfma_f32_32x32x16_bf16 v[96:111], v[52:55], v[44:47], v[96:111]
    ds_read_b128 v[132:135], v13 offset:61440
    ds_read_b128 v[92:95], v14 offset:57344
    ds_read_b64_tr_b16 v[16:17], v20 offset:4096
    v_mfma_f32_32x32x16_bf16 v[112:127], v[52:55], v[48:51], v[112:127]
    ds_read_b64_tr_b16 v[18:19], v20 offset:4608
    ds_read_b128 v[140:143], v14 offset:61440
    ds_read_b128 v[4:7], v15 offset:57344
    v_mfma_f32_32x32x16_bf16 v[96:111], v[64:67], v[56:59], v[96:111]
    ds_read_b64_tr_b16 v[164:165], v20 offset:6144
    ds_read_b64_tr_b16 v[166:167], v20 offset:6656
    ds_read_b128 v[160:163], v15 offset:61440
    v_mfma_f32_32x32x16_bf16 v[112:127], v[64:67], v[60:63], v[112:127]
    v_mfma_f32_32x32x16_bf16 v[96:111], v[76:79], v[68:71], v[96:111]
    v_mfma_f32_32x32x16_bf16 v[112:127], v[76:79], v[72:75], v[112:127]
    s_waitcnt lgkmcnt(0)
    s_barrier
    v_mfma_f32_32x32x16_bf16 v[96:111], v[88:91], v[80:83], v[96:111]
    v_mfma_f32_32x32x16_bf16 v[112:127], v[88:91], v[84:87], v[112:127]
    v_mfma_f32_32x32x16_bf16 v[96:111], v[136:139], v[128:131], v[96:111]
    v_mfma_f32_32x32x16_bf16 v[112:127], v[136:139], v[132:135], v[112:127]
    v_mfma_f32_32x32x16_bf16 v[96:111], v[16:19], v[92:95], v[96:111]
    v_mfma_f32_32x32x16_bf16 v[112:127], v[16:19], v[140:143], v[112:127]
    v_mfma_f32_32x32x16_bf16 v[96:111], v[164:167], v[4:7], v[96:111]
    v_mfma_f32_32x32x16_bf16 v[112:127], v[164:167], v[160:163], v[112:127]
    s_barrier
    s_nop 10
    v_cvt_pk_bf16_f32 v64, v96, v97
    v_cvt_pk_bf16_f32 v65, v98, v99
    v_cvt_pk_bf16_f32 v66, v100, v101
    v_cvt_pk_bf16_f32 v67, v102, v103
    v_cvt_pk_bf16_f32 v72, v112, v113
    v_cvt_pk_bf16_f32 v73, v114, v115
    v_cvt_pk_bf16_f32 v74, v116, v117
    v_cvt_pk_bf16_f32 v75, v118, v119
    v_cvt_pk_bf16_f32 v88, v104, v105
    v_cvt_pk_bf16_f32 v89, v106, v107
    v_cvt_pk_bf16_f32 v90, v108, v109
    v_cvt_pk_bf16_f32 v91, v110, v111
    v_cvt_pk_bf16_f32 v92, v120, v121
    v_cvt_pk_bf16_f32 v93, v122, v123
    v_cvt_pk_bf16_f32 v94, v124, v125
    v_cvt_pk_bf16_f32 v95, v126, v127
    s_barrier
    v_mfma_f32_32x32x16_bf16 v[32:47], v[144:147], v[64:67], 0
    v_mfma_f32_32x32x16_bf16 v[48:63], v[144:147], v[72:75], 0
    s_barrier
    v_mfma_f32_32x32x16_bf16 v[96:111], v[88:91], v[148:151], 0
    v_mfma_f32_32x32x16_bf16 v[112:127], v[92:95], v[148:151], 0
    s_nop 8
    v_max3_f32 v80, v32, v33, v34
    v_max3_f32 v84, v48, v49, v50
    s_barrier
    v_max3_f32 v82, -v32, -v33, -v34
    v_max3_f32 v86, -v48, -v49, -v50
    v_max3_f32 v80, v80, v35, v36
    v_max3_f32 v84, v84, v51, v52
    v_max3_f32 v82, v82, -v35, -v36
    v_max3_f32 v86, v86, -v51, -v52
    v_max3_f32 v80, v80, v37, v38
    v_max3_f32 v84, v84, v53, v54
    v_max3_f32 v82, v82, -v37, -v38
    v_max3_f32 v86, v86, -v53, -v54
    v_max_f32 v80, v80, v39
    v_max_f32 v84, v84, v55
    v_max_f32_e64 v82, v82, -v39
    v_max_f32_e64 v86, v86, -v55
    s_nop 0
    v_permlane32_swap_b32 v80, v82
    v_permlane32_swap_b32 v84, v86
    s_nop 1
    v_max_f32 v80, v80, v82
    v_max_f32 v84, v84, v86
    v_mul_f32 v80, s75, v80
    v_mul_f32 v84, s75, v84
    v_mov_b32 v82, v80
    v_mov_b32 v86, v84
    s_nop 0
    v_permlane32_swap_b32 v80, v82
    v_permlane32_swap_b32 v84, v86
    s_nop 1
    v_pk_fma_f32 v[40:41], v[32:33], s[74:75], v[82:83] op_sel_hi:[1,0,0] neg_lo:[1,0,0] neg_hi:[1,0,0]
    v_pk_fma_f32 v[56:57], v[48:49], s[74:75], v[86:87] op_sel_hi:[1,0,0] neg_lo:[1,0,0] neg_hi:[1,0,0]
    v_pk_fma_f32 v[32:33], v[32:33], s[74:75], v[80:81] op_sel_hi:[1,0,0]
    v_pk_fma_f32 v[48:49], v[48:49], s[74:75], v[84:85] op_sel_hi:[1,0,0]
    v_pk_fma_f32 v[42:43], v[34:35], s[74:75], v[82:83] op_sel_hi:[1,0,0] neg_lo:[1,0,0] neg_hi:[1,0,0]
    s_barrier
    v_pk_fma_f32 v[58:59], v[50:51], s[74:75], v[86:87] op_sel_hi:[1,0,0] neg_lo:[1,0,0] neg_hi:[1,0,0]
    v_pk_fma_f32 v[34:35], v[34:35], s[74:75], v[80:81] op_sel_hi:[1,0,0]
    v_pk_fma_f32 v[50:51], v[50:51], s[74:75], v[84:85] op_sel_hi:[1,0,0]
    v_pk_fma_f32 v[44:45], v[36:37], s[74:75], v[82:83] op_sel_hi:[1,0,0] neg_lo:[1,0,0] neg_hi:[1,0,0]
    v_pk_fma_f32 v[60:61], v[52:53], s[74:75], v[86:87] op_sel_hi:[1,0,0] neg_lo:[1,0,0] neg_hi:[1,0,0]
    v_pk_fma_f32 v[36:37], v[36:37], s[74:75], v[80:81] op_sel_hi:[1,0,0]
    v_pk_fma_f32 v[52:53], v[52:53], s[74:75], v[84:85] op_sel_hi:[1,0,0]
    v_pk_fma_f32 v[46:47], v[38:39], s[74:75], v[82:83] op_sel_hi:[1,0,0] neg_lo:[1,0,0] neg_hi:[1,0,0]
    v_pk_fma_f32 v[62:63], v[54:55], s[74:75], v[86:87] op_sel_hi:[1,0,0] neg_lo:[1,0,0] neg_hi:[1,0,0]
    v_pk_fma_f32 v[38:39], v[38:39], s[74:75], v[80:81] op_sel_hi:[1,0,0]
    v_pk_fma_f32 v[54:55], v[54:55], s[74:75], v[84:85] op_sel_hi:[1,0,0]
    v_exp_f32 v32, v32
    v_exp_f32 v48, v48
    v_exp_f32 v33, v33
    v_exp_f32 v49, v49
    v_exp_f32 v34, v34
    v_exp_f32 v50, v50
    v_exp_f32 v35, v35
    v_exp_f32 v51, v51
    v_exp_f32 v36, v36
    v_exp_f32 v52, v52
    v_exp_f32 v37, v37
    v_exp_f32 v53, v53
    s_barrier
    v_exp_f32 v38, v38
    v_exp_f32 v54, v54
    v_exp_f32 v39, v39
    v_exp_f32 v55, v55
    v_exp_f32 v40, v40
    v_exp_f32 v56, v56
    v_exp_f32 v41, v41
    v_exp_f32 v57, v57
    v_exp_f32 v42, v42
    v_exp_f32 v58, v58
    v_exp_f32 v43, v43
    v_exp_f32 v59, v59
    v_exp_f32 v44, v44
    v_exp_f32 v60, v60
    v_exp_f32 v45, v45
    v_exp_f32 v61, v61
    v_exp_f32 v46, v46
    s_barrier
    v_exp_f32 v62, v62
    v_exp_f32 v47, v47
    v_exp_f32 v63, v63
    v_pk_add_f32 v[64:65], v[32:33], v[34:35]
    v_pk_add_f32 v[72:73], v[48:49], v[50:51]
    v_pk_add_f32 v[66:67], v[36:37], v[38:39]
    v_pk_add_f32 v[74:75], v[52:53], v[54:55]
    v_pk_add_f32 v[68:69], v[40:41], v[42:43]
    v_pk_add_f32 v[76:77], v[56:57], v[58:59]
    v_pk_add_f32 v[70:71], v[44:45], v[46:47]
    v_pk_add_f32 v[78:79], v[60:61], v[62:63]
    v_pk_add_f32 v[64:65], v[64:65], v[66:67]
    v_pk_add_f32 v[72:73], v[72:73], v[74:75]
    v_pk_add_f32 v[68:69], v[68:69], v[70:71]
    v_pk_add_f32 v[76:77], v[76:77], v[78:79]
    v_add_f32 v80, v64, v65
    v_add_f32 v84, v72, v73
    v_add_f32 v82, v68, v69
    v_add_f32 v86, v76, v77
    s_nop 0
    v_permlane32_swap_b32 v80, v82
    v_permlane32_swap_b32 v84, v86
    s_nop 1
    v_add_f32 v80, v80, v82
    v_add_f32 v84, v84, v86
    v_rcp_f32 v80, v80
    v_rcp_f32 v84, v84
    v_mov_b32 v82, v80
    v_mov_b32 v86, v84
    s_nop 0
    v_permlane32_swap_b32 v80, v82
    v_permlane32_swap_b32 v84, v86
    s_nop 1
    v_pk_mul_f32 v[32:33], v[32:33], v[80:81] op_sel_hi:[1,0]
    v_pk_mul_f32 v[48:49], v[48:49], v[84:85] op_sel_hi:[1,0]
    v_pk_mul_f32 v[40:41], v[40:41], v[82:83] op_sel_hi:[1,0]
    v_pk_mul_f32 v[56:57], v[56:57], v[86:87] op_sel_hi:[1,0]
    v_pk_mul_f32 v[34:35], v[34:35], v[80:81] op_sel_hi:[1,0]
    v_pk_mul_f32 v[50:51], v[50:51], v[84:85] op_sel_hi:[1,0]
    v_pk_mul_f32 v[42:43], v[42:43], v[82:83] op_sel_hi:[1,0]
    v_pk_mul_f32 v[58:59], v[58:59], v[86:87] op_sel_hi:[1,0]
    v_pk_mul_f32 v[36:37], v[36:37], v[80:81] op_sel_hi:[1,0]
    v_pk_mul_f32 v[52:53], v[52:53], v[84:85] op_sel_hi:[1,0]
    v_pk_mul_f32 v[44:45], v[44:45], v[82:83] op_sel_hi:[1,0]
    v_pk_mul_f32 v[60:61], v[60:61], v[86:87] op_sel_hi:[1,0]
    v_pk_mul_f32 v[38:39], v[38:39], v[80:81] op_sel_hi:[1,0]
    v_pk_mul_f32 v[54:55], v[54:55], v[84:85] op_sel_hi:[1,0]
    v_pk_mul_f32 v[46:47], v[46:47], v[82:83] op_sel_hi:[1,0]
    v_pk_mul_f32 v[62:63], v[62:63], v[86:87] op_sel_hi:[1,0]
    v_cvt_pk_bf16_f32 v64, v32, v33
    v_cvt_pk_bf16_f32 v72, v48, v49
    v_cvt_pk_bf16_f32 v65, v34, v35
    v_cvt_pk_bf16_f32 v73, v50, v51
    v_cvt_pk_bf16_f32 v66, v36, v37
    v_cvt_pk_bf16_f32 v74, v52, v53
    v_cvt_pk_bf16_f32 v67, v38, v39
    v_cvt_pk_bf16_f32 v75, v54, v55
    v_cvt_pk_bf16_f32 v68, v40, v41
    v_cvt_pk_bf16_f32 v76, v56, v57
    v_cvt_pk_bf16_f32 v69, v42, v43
    v_cvt_pk_bf16_f32 v77, v58, v59
    v_cvt_pk_bf16_f32 v70, v44, v45
    v_cvt_pk_bf16_f32 v78, v60, v61
    v_cvt_pk_bf16_f32 v71, v46, v47
    v_cvt_pk_bf16_f32 v79, v62, v63
    s_barrier
    s_setprio 2
    v_mfma_f32_32x32x16_bf16 v[32:47], v[64:67], v[148:151], 0
    v_mfma_f32_32x32x16_bf16 v[48:63], v[72:75], v[148:151], 0
    v_mfma_f32_32x32x16_bf16 v[32:47], v[68:71], v[152:155], v[32:47]
    v_mfma_f32_32x32x16_bf16 v[48:63], v[76:79], v[152:155], v[48:63]
    v_cvt_pk_bf16_f32 v96, v96, v97
    v_cvt_pk_bf16_f32 v97, v98, v99
    v_cvt_pk_bf16_f32 v98, v100, v101
    v_cvt_pk_bf16_f32 v99, v102, v103
    v_cvt_pk_bf16_f32 v100, v104, v105
    v_cvt_pk_bf16_f32 v101, v106, v107
    v_cvt_pk_bf16_f32 v102, v108, v109
    v_cvt_pk_bf16_f32 v103, v110, v111
    v_or_b32 v96, v96, v156
    v_or_b32 v97, v97, v156
    v_or_b32 v98, v98, v156
    v_or_b32 v99, v99, v156
    v_or_b32 v100, v100, v156
    v_or_b32 v101, v101, v156
    v_or_b32 v102, v102, v156
    v_or_b32 v103, v103, v156
    v_cvt_pk_bf16_f32 v112, v112, v113
    v_cvt_pk_bf16_f32 v113, v114, v115
    v_cvt_pk_bf16_f32 v114, v116, v117
    v_cvt_pk_bf16_f32 v115, v118, v119
    v_cvt_pk_bf16_f32 v116, v120, v121
    v_cvt_pk_bf16_f32 v117, v122, v123
    v_cvt_pk_bf16_f32 v118, v124, v125
    v_cvt_pk_bf16_f32 v119, v126, v127
    v_or_b32 v112, v112, v156
    v_or_b32 v113, v113, v156
    v_or_b32 v114, v114, v156
    v_or_b32 v115, v115, v156
    v_or_b32 v116, v116, v156
    v_or_b32 v117, v117, v156
    v_or_b32 v118, v118, v156
    v_or_b32 v119, v119, v156
    v_cvt_pk_bf16_f32 v64, v32, v33
    v_cvt_pk_bf16_f32 v65, v34, v35
    v_cvt_pk_bf16_f32 v66, v36, v37
    v_cvt_pk_bf16_f32 v67, v38, v39
    v_cvt_pk_bf16_f32 v68, v40, v41
    v_cvt_pk_bf16_f32 v69, v42, v43
    v_cvt_pk_bf16_f32 v70, v44, v45
    v_cvt_pk_bf16_f32 v71, v46, v47
    v_cvt_pk_bf16_f32 v72, v48, v49
    v_cvt_pk_bf16_f32 v73, v50, v51
    v_cvt_pk_bf16_f32 v74, v52, v53
    v_cvt_pk_bf16_f32 v75, v54, v55
    v_cvt_pk_bf16_f32 v76, v56, v57
    v_cvt_pk_bf16_f32 v77, v58, v59
    v_cvt_pk_bf16_f32 v78, v60, v61
    v_cvt_pk_bf16_f32 v79, v62, v63
    v_mfma_f32_32x32x16_bf16 v[128:143], v[64:67], v[96:99], 0
    v_mfma_f32_32x32x16_bf16 v[128:143], v[68:71], v[100:103], v[128:143]
    v_mfma_f32_32x32x16_bf16 v[128:143], v[72:75], v[112:115], v[128:143]
    v_mfma_f32_32x32x16_bf16 v[128:143], v[76:79], v[116:119], v[128:143]
    ds_read_b128 v[4:7], v28
    v_mov_b32 v2, v10
    v_mov_b32 v3, 0xdddddddd
    v_and_b32 v106, 27, v1
    v_mov_b32 v107, 0x3f803f80
    v_cmp_eq_u32 vcc, 16, v106
    s_mov_b32 s20, 0xffff
    s_mov_b32 s21, 0xffff
    v_cndmask_b32 v144, 0, v107, vcc
    v_mov_b32 v145, v144
    v_mov_b64 v[146:147], v[144:145]
    v_mov_b64 v[148:149], v[144:145]
    v_mov_b64 v[150:151], v[144:145]
    v_mov_b64 v[152:153], v[144:145]
    v_mov_b64 v[154:155], v[144:145]
    v_mov_b64 v[156:157], v[144:145]
    v_mov_b64 v[158:159], v[144:145]
    s_mov_b32 s22, 2
    s_mov_b32 s23, 0
    s_branch L_attn
L_qwave:
    v_lshrrev_b32 v22, 5, v1
    v_bfe_u32 v23, v1, 2, 2
    v_lshl_add_u32 v20, v22, 3, v23
    v_lshlrev_b32 v20, 7, v20
    v_bfe_u32 v23, v1, 3, 2
    v_xor_b32 v23, s44, v23
    v_lshl_add_u32 v20, v23, 5, v20
    v_bfe_u32 v24, v1, 4, 1
    v_lshl_add_u32 v20, v24, 13, v20
    v_and_b32 v23, 3, v1
    v_lshl_add_u32 v20, v23, 3, v20
    s_lshl_b32 s45, s29, 2
    s_add_u32 s45, s45, s44
    s_lshl_b32 s47, s28, 1
    s_xor_b32 s46, s40, 1
    s_add_u32 s47, s47, s46
    s_lshl_b32 s43, s47, 6
    s_add_u32 s43, s43, s45
    s_lshl_b32 s43, s43, 10
    s_add_u32 s43, s43, 5275648
    s_mov_b32 s74, 0x3fb8aa3b
    s_mov_b32 s75, 0xbfb8aa3b
    s_mov_b32 s76, 0x3eb8aa3b
    s_lshl_b32 s38, s44, 10
    s_add_u32 s38, s38, 147456
    v_add_u32 v28, s38, v10
    v_mov_b32 v2, v10
    v_mov_b32 v3, 0xdddddddd
    v_and_b32 v106, 27, v1
    v_mov_b32 v107, 0x3f803f80
    v_cmp_eq_u32 vcc, 16, v106
    s_mov_b32 s20, 0xffff
    s_mov_b32 s21, 0xffff
    v_cndmask_b32 v144, 0, v107, vcc
    v_mov_b32 v145, v144
    v_mov_b64 v[146:147], v[144:145]
    v_mov_b64 v[148:149], v[144:145]
    v_mov_b64 v[150:151], v[144:145]
    v_mov_b64 v[152:153], v[144:145]
    v_mov_b64 v[154:155], v[144:145]
    v_mov_b64 v[156:157], v[144:145]
    v_mov_b64 v[158:159], v[144:145]
    s_mov_b32 s22, 2
    s_mov_b32 s23, 0
    s_lshl_b32 s38, s44, 11
    s_add_u32 s38, s38, 131072
    v_add_u32 v29, s38, v10
    s_mov_b32 s41, 0
    s_waitcnt lgkmcnt(0)
    s_mov_b32 s24, s72
    s_mov_b32 s25, s73
    s_mov_b32 s26, 0xb00000
    s_mov_b32 s27, 0x00020000
    s_cmp_eq_u32 s30, 6
    s_cbranch_scc1 L_touch
    s_cmp_eq_u32 s30, 7
    s_cbranch_scc1 L_touch7
    s_cmp_gt_u32 s3, 2
    s_cbranch_scc1 L_qidle
    s_lshl_b32 s38, s44, 12
    v_add_u32 v16, s38, v12
    v_add_u32 v17, s38, v13
    v_add_u32 v18, s38, v14
    v_add_u32 v19, s38, v15
    v_and_b32 v23, 15, v1
    v_lshlrev_b32 v23, 3, v23
    v_lshl_add_u32 v26, v22, 8, v23
    v_lshlrev_b32 v27, 4, v22
    s_lshl_b32 s42, s28, 1
    s_add_u32 s42, s42, s44
    s_cmp_eq_u32 s3, 2
    s_cbranch_scc1 L_qgate
    v_and_b32 v11, 31, v1
    v_lshrrev_b32 v22, 5, v1
    v_lshlrev_b32 v22, 2, v22
    v_sub_u32 v11, v11, v22
    v_mov_b32 v22, 0x3f80
    v_mov_b32 v23, 0x3f800000
    v_cmp_eq_u32 vcc, 0, v11
    v_cmp_eq_u32 s[38:39], 1, v11
    s_nop 0
    v_cndmask_b32 v160, 0, v22, vcc
    v_cndmask_b32 v160, v160, v23, s[38:39]
    v_cmp_eq_u32 vcc, 2, v11
    v_cmp_eq_u32 s[38:39], 3, v11
    s_nop 0
    v_cndmask_b32 v161, 0, v22, vcc
    v_cndmask_b32 v161, v161, v23, s[38:39]
    v_cmp_eq_u32 vcc, 8, v11
    v_cmp_eq_u32 s[38:39], 9, v11
    s_nop 0
    v_cndmask_b32 v162, 0, v22, vcc
    v_cndmask_b32 v162, v162, v23, s[38:39]
    v_cmp_eq_u32 vcc, 10, v11
    v_cmp_eq_u32 s[38:39], 11, v11
    s_nop 0
    v_cndmask_b32 v163, 0, v22, vcc
    v_cndmask_b32 v163, v163, v23, s[38:39]
    s_lshl_b32 s38, s31, 11
    v_add_u32 v21, s38, v26
    s_add_u32 s31, s31, 1
    s_and_b32 s31, s31, 7
    s_lshl_b32 s38, s31, 11
    v_add_u32 v25, s38, v26
    s_add_u32 s31, s31, 1
    s_and_b32 s31, s31, 7
    s_barrier
    ds_read_b128 v[32:35], v16 offset:0
    ds_read_b64_tr_b16 v[36:37], v21 offset:0
    ds_read_b64_tr_b16 v[38:39], v21 offset:128
    ds_read_b128 v[40:43], v17 offset:0
    ds_read_b64_tr_b16 v[44:45], v21 offset:512
    ds_read_b64_tr_b16 v[46:47], v21 offset:640
    ds_read_b128 v[48:51], v18 offset:0
    ds_read_b64_tr_b16 v[52:53], v21 offset:1024
    ds_read_b64_tr_b16 v[54:55], v21 offset:1152
    ds_read_b128 v[56:59], v19 offset:0
    ds_read_b64_tr_b16 v[60:61], v21 offset:1536
    ds_read_b64_tr_b16 v[62:63], v21 offset:1664
    ds_read_b128 v[64:67], v16 offset:8192
    ds_read_b64_tr_b16 v[68:69], v25 offset:0
    ds_read_b64_tr_b16 v[70:71], v25 offset:128
    ds_read_b128 v[72:75], v17 offset:8192
    ds_read_b64_tr_b16 v[76:77], v25 offset:512
    ds_read_b64_tr_b16 v[78:79], v25 offset:640
    ds_read_b128 v[80:83], v18 offset:8192
    ds_read_b64_tr_b16 v[84:85], v25 offset:1024
    ds_read_b64_tr_b16 v[86:87], v25 offset:1152
    ds_read_b128 v[88:91], v19 offset:8192
    ds_read_b64_tr_b16 v[92:93], v25 offset:1536
    ds_read_b64_tr_b16 v[94:95], v25 offset:1664
    s_waitcnt lgkmcnt(12)
    v_mfma_f32_32x32x16_bf16 v[128:143], v[36:39], v[32:35], 0
    v_mfma_f32_32x32x16_bf16 v[128:143], v[44:47], v[40:43], v[128:143]
    v_mfma_f32_32x32x16_bf16 v[128:143], v[52:55], v[48:51], v[128:143]
    v_mfma_f32_32x32x16_bf16 v[128:143], v[60:63], v[56:59], v[128:143]
    s_waitcnt lgkmcnt(0)
    s_lshl_b32 s38, s31, 11
    v_add_u32 v21, s38, v26
    s_add_u32 s31, s31, 1
    s_and_b32 s31, s31, 7
    s_lshl_b32 s38, s31, 11
    v_add_u32 v25, s38, v26
    s_add_u32 s31, s31, 1
    s_and_b32 s31, s31, 7
    s_barrier
    v_mfma_f32_32x32x16_bf16 v[128:143], v[68:71], v[64:67], v[128:143]
    ds_read_b128 v[96:99], v16 offset:16384
    ds_read_b64_tr_b16 v[100:101], v21 offset:0
    ds_read_b64_tr_b16 v[102:103], v21 offset:128
    ds_read_b128 v[104:107], v17 offset:16384
    ds_read_b64_tr_b16 v[108:109], v21 offset:512
    ds_read_b64_tr_b16 v[110:111], v21 offset:640
    ds_read_b128 v[112:115], v18 offset:16384
    ds_read_b64_tr_b16 v[116:117], v21 offset:1024
    v_mfma_f32_32x32x16_bf16 v[128:143], v[76:79], v[72:75], v[128:143]
    ds_read_b64_tr_b16 v[118:119], v21 offset:1152
    ds_read_b128 v[120:123], v19 offset:16384
    ds_read_b64_tr_b16 v[124:125], v21 offset:1536
    ds_read_b64_tr_b16 v[126:127], v21 offset:1664
    ds_read_b128 v[32:35], v16 offset:24576
    ds_read_b64_tr_b16 v[36:37], v25 offset:0
    ds_read_b64_tr_b16 v[38:39], v25 offset:128
    ds_read_b128 v[40:43], v17 offset:24576
    v_mfma_f32_32x32x16_bf16 v[128:143], v[84:87], v[80:83], v[128:143]
    ds_read_b64_tr_b16 v[44:45], v25 offset:512
    ds_read_b64_tr_b16 v[46:47], v25 offset:640
    ds_read_b128 v[48:51], v18 offset:24576
    ds_read_b64_tr_b16 v[52:53], v25 offset:1024
    ds_read_b64_tr_b16 v[54:55], v25 offset:1152
    ds_read_b128 v[56:59], v19 offset:24576
    ds_read_b64_tr_b16 v[60:61], v25 offset:1536
    ds_read_b64_tr_b16 v[62:63], v25 offset:1664
    v_mfma_f32_32x32x16_bf16 v[128:143], v[92:95], v[88:91], v[128:143]
    s_waitcnt lgkmcnt(12)
    v_mfma_f32_32x32x16_bf16 v[128:143], v[100:103], v[96:99], v[128:143]
    v_mfma_f32_32x32x16_bf16 v[128:143], v[108:111], v[104:107], v[128:143]
    v_mfma_f32_32x32x16_bf16 v[128:143], v[116:119], v[112:115], v[128:143]
    v_mfma_f32_32x32x16_bf16 v[128:143], v[124:127], v[120:123], v[128:143]
    s_waitcnt lgkmcnt(0)
    s_lshl_b32 s38, s31, 11
    v_add_u32 v21, s38, v26
    s_add_u32 s31, s31, 1
    s_and_b32 s31, s31, 7
    s_lshl_b32 s38, s31, 11
    v_add_u32 v25, s38, v26
    s_add_u32 s31, s31, 1
    s_and_b32 s31, s31, 7
    s_barrier
    v_mfma_f32_32x32x16_bf16 v[128:143], v[36:39], v[32:35], v[128:143]
    ds_read_b128 v[64:67], v16 offset:32768
    ds_read_b64_tr_b16 v[68:69], v21 offset:0
    ds_read_b64_tr_b16 v[70:71], v21 offset:128
    ds_read_b128 v[72:75], v17 offset:32768
    ds_read_b64_tr_b16 v[76:77], v21 offset:512
    ds_read_b64_tr_b16 v[78:79], v21 offset:640
    ds_read_b128 v[80:83], v18 offset:32768
    ds_read_b64_tr_b16 v[84:85], v21 offset:1024
    v_mfma_f32_32x32x16_bf16 v[128:143], v[44:47], v[40:43], v[128:143]
    ds_read_b64_tr_b16 v[86:87], v21 offset:1152
    ds_read_b128 v[88:91], v19 offset:32768
    ds_read_b64_tr_b16 v[92:93], v21 offset:1536
    ds_read_b64_tr_b16 v[94:95], v21 offset:1664
    ds_read_b128 v[96:99], v16 offset:40960
    ds_read_b64_tr_b16 v[100:101], v25 offset:0
    ds_read_b64_tr_b16 v[102:103], v25 offset:128
    ds_read_b128 v[104:107], v17 offset:40960
    v_mfma_f32_32x32x16_bf16 v[128:143], v[52:55], v[48:51], v[128:143]
    ds_read_b64_tr_b16 v[108:109], v25 offset:512
    ds_read_b64_tr_b16 v[110:111], v25 offset:640
    ds_read_b128 v[112:115], v18 offset:40960
    ds_read_b64_tr_b16 v[116:117], v25 offset:1024
    ds_read_b64_tr_b16 v[118:119], v25 offset:1152
    ds_read_b128 v[120:123], v19 offset:40960
    ds_read_b64_tr_b16 v[124:125], v25 offset:1536
    ds_read_b64_tr_b16 v[126:127], v25 offset:1664
    v_mfma_f32_32x32x16_bf16 v[128:143], v[60:63], v[56:59], v[128:143]
    s_waitcnt lgkmcnt(12)
    v_mfma_f32_32x32x16_bf16 v[128:143], v[68:71], v[64:67], v[128:143]
    v_mfma_f32_32x32x16_bf16 v[128:143], v[76:79], v[72:75], v[128:143]
    v_mfma_f32_32x32x16_bf16 v[128:143], v[84:87], v[80:83], v[128:143]
    v_mfma_f32_32x32x16_bf16 v[128:143], v[92:95], v[88:91], v[128:143]
    s_waitcnt lgkmcnt(0)
    s_lshl_b32 s38, s31, 11
    v_add_u32 v21, s38, v26
    s_add_u32 s31, s31, 1
    s_and_b32 s31, s31, 7
    s_lshl_b32 s38, s31, 11
    v_add_u32 v25, s38, v26
    s_add_u32 s31, s31, 1
    s_and_b32 s31, s31, 7
    s_barrier
    v_mfma_f32_32x32x16_bf16 v[128:143], v[100:103], v[96:99], v[128:143]
    ds_read_b128 v[32:35], v16 offset:49152
    ds_read_b64_tr_b16 v[36:37], v21 offset:0
    ds_read_b64_tr_b16 v[38:39], v21 offset:128
    ds_read_b128 v[40:43], v17 offset:49152
    ds_read_b64_tr_b16 v[44:45], v21 offset:512
    ds_read_b64_tr_b16 v[46:47], v21 offset:640
    ds_read_b128 v[48:51], v18 offset:49152
    ds_read_b64_tr_b16 v[52:53], v21 offset:1024
    v_mfma_f32_32x32x16_bf16 v[128:143], v[108:111], v[104:107], v[128:143]
    ds_read_b64_tr_b16 v[54:55], v21 offset:1152
    ds_read_b128 v[56:59], v19 offset:49152
    ds_read_b64_tr_b16 v[60:61], v21 offset:1536
    ds_read_b64_tr_b16 v[62:63], v21 offset:1664
    ds_read_b128 v[64:67], v16 offset:57344
    ds_read_b64_tr_b16 v[68:69], v25 offset:0
    ds_read_b64_tr_b16 v[70:71], v25 offset:128
    ds_read_b128 v[72:75], v17 offset:57344
    v_mfma_f32_32x32x16_bf16 v[128:143], v[116:119], v[112:115], v[128:143]
    ds_read_b64_tr_b16 v[76:77], v25 offset:512
    ds_read_b64_tr_b16 v[78:79], v25 offset:640
    ds_read_b128 v[80:83], v18 offset:57344
    ds_read_b64_tr_b16 v[84:85], v25 offset:1024
    ds_read_b64_tr_b16 v[86:87], v25 offset:1152
    ds_read_b128 v[88:91], v19 offset:57344
    ds_read_b64_tr_b16 v[92:93], v25 offset:1536
    ds_read_b64_tr_b16 v[94:95], v25 offset:1664
    v_mfma_f32_32x32x16_bf16 v[128:143], v[124:127], v[120:123], v[128:143]
    s_waitcnt lgkmcnt(12)
    v_mfma_f32_32x32x16_bf16 v[128:143], v[36:39], v[32:35], v[128:143]
    v_mfma_f32_32x32x16_bf16 v[128:143], v[44:47], v[40:43], v[128:143]
    v_mfma_f32_32x32x16_bf16 v[128:143], v[52:55], v[48:51], v[128:143]
    v_mfma_f32_32x32x16_bf16 v[128:143], v[60:63], v[56:59], v[128:143]
    s_waitcnt lgkmcnt(0)
    s_barrier
    v_mfma_f32_32x32x16_bf16 v[128:143], v[68:71], v[64:67], v[128:143]
    v_mfma_f32_32x32x16_bf16 v[128:143], v[76:79], v[72:75], v[128:143]
    v_mfma_f32_32x32x16_bf16 v[128:143], v[84:87], v[80:83], v[128:143]
    v_mfma_f32_32x32x16_bf16 v[128:143], v[92:95], v[88:91], v[128:143]
    s_nop 11
    v_cvt_pk_bf16_f32 v128, v128, v129
    v_cvt_pk_bf16_f32 v129, v130, v131
    v_cvt_pk_bf16_f32 v130, v132, v133
    v_cvt_pk_bf16_f32 v131, v134, v135
    s_lshl_b32 s38, s42, 11
    s_lshl_b32 s41, s44, 1
    s_add_u32 s41, s41, s3
    s_lshl_b32 s41, s41, 5
    s_add_u32 s41, s41, s28
    s_lshl_b32 s41, s41, 3
    s_add_u32 s41, s41, 180224
    s_cmp_eq_u32 s3, 1
    s_cbranch_scc1 L_qv
    buffer_store_dwordx4 v[128:131], v10, s[24:27], s38 offen sc1
    s_branch L_q5
L_qv:
    s_nop 1
    v_mfma_f32_32x32x16_bf16 v[32:47], v[128:131], v[160:163], 0
    s_nop 11
    v_cvt_pk_bf16_f32 v136, v32, v33
    v_cvt_pk_bf16_f32 v137, v34, v35
    v_cvt_pk_bf16_f32 v138, v36, v37
    v_cvt_pk_bf16_f32 v139, v38, v39
    v_cvt_pk_bf16_f32 v140, v40, v41
    v_cvt_pk_bf16_f32 v141, v42, v43
    v_cvt_pk_bf16_f32 v142, v44, v45
    v_cvt_pk_bf16_f32 v143, v46, v47
    v_permlane32_swap_b32 v136, v138
    v_permlane32_swap_b32 v137, v139
    v_permlane32_swap_b32 v140, v142
    v_permlane32_swap_b32 v141, v143
    s_mov_b32 exec_lo, 0xffff
    s_mov_b32 exec_hi, 0xffff
    buffer_store_dwordx4 v[136:139], v10, s[24:27], s38 offen offset:1024 sc1
    buffer_store_dwordx4 v[140:143], v10, s[24:27], s38 offen offset:1280 sc1
    s_mov_b64 exec, -1
    s_branch L_q5
L_qgate:
    s_lshl_b32 s38, s31, 7
    v_add_u32 v21, s38, v27
    s_add_u32 s31, s31, 1
    s_and_b32 s31, s31, 7
    s_lshl_b32 s38, s31, 7
    v_add_u32 v25, s38, v27
    s_add_u32 s31, s31, 1
    s_and_b32 s31, s31, 7
    s_barrier
    ds_read_b128 v[32:35], v16 offset:0
    ds_read_b128 v[36:39], v21 offset:0
    ds_read_b128 v[40:43], v17 offset:0
    ds_read_b128 v[44:47], v21 offset:32
    ds_read_b128 v[48:51], v18 offset:0
    ds_read_b128 v[52:55], v21 offset:64
    ds_read_b128 v[56:59], v19 offset:0
    ds_read_b128 v[60:63], v21 offset:96
    ds_read_b128 v[64:67], v16 offset:8192
    ds_read_b128 v[68:71], v25 offset:0
    ds_read_b128 v[72:75], v17 offset:8192
    ds_read_b128 v[76:79], v25 offset:32
    ds_read_b128 v[80:83], v18 offset:8192
    ds_read_b128 v[84:87], v25 offset:64
    ds_read_b128 v[88:91], v19 offset:8192
    ds_read_b128 v[92:95], v25 offset:96
    s_waitcnt lgkmcnt(8)
    v_mfma_f32_32x32x16_bf16 v[128:143], v[36:39], v[32:35], 0
    v_mfma_f32_32x32x16_bf16 v[128:143], v[44:47], v[40:43], v[128:143]
    v_mfma_f32_32x32x16_bf16 v[128:143], v[52:55], v[48:51], v[128:143]
    v_mfma_f32_32x32x16_bf16 v[128:143], v[60:63], v[56:59], v[128:143]
    s_waitcnt lgkmcnt(0)
    s_lshl_b32 s38, s31, 7
    v_add_u32 v21, s38, v27
    s_add_u32 s31, s31, 1
    s_and_b32 s31, s31, 7
    s_lshl_b32 s38, s31, 7
    v_add_u32 v25, s38, v27
    s_add_u32 s31, s31, 1
    s_and_b32 s31, s31, 7
    s_barrier
    v_mfma_f32_32x32x16_bf16 v[128:143], v[68:71], v[64:67], v[128:143]
    ds_read_b128 v[96:99], v16 offset:16384
    ds_read_b128 v[100:103], v21 offset:0
    ds_read_b128 v[104:107], v17 offset:16384
    ds_read_b128 v[108:111], v21 offset:32
    ds_read_b128 v[112:115], v18 offset:16384
    ds_read_b128 v[116:119], v21 offset:64
    v_mfma_f32_32x32x16_bf16 v[128:143], v[76:79], v[72:75], v[128:143]
    ds_read_b128 v[120:123], v19 offset:16384
    ds_read_b128 v[124:127], v21 offset:96
    ds_read_b128 v[32:35], v16 offset:24576
    ds_read_b128 v[36:39], v25 offset:0
    ds_read_b128 v[40:43], v17 offset:24576
    v_mfma_f32_32x32x16_bf16 v[128:143], v[84:87], v[80:83], v[128:143]
    ds_read_b128 v[44:47], v25 offset:32
    ds_read_b128 v[48:51], v18 offset:24576
    ds_read_b128 v[52:55], v25 offset:64
    ds_read_b128 v[56:59], v19 offset:24576
    ds_read_b128 v[60:63], v25 offset:96
    v_mfma_f32_32x32x16_bf16 v[128:143], v[92:95], v[88:91], v[128:143]
    s_waitcnt lgkmcnt(8)
    v_mfma_f32_32x32x16_bf16 v[128:143], v[100:103], v[96:99], v[128:143]
    v_mfma_f32_32x32x16_bf16 v[128:143], v[108:111], v[104:107], v[128:143]
    v_mfma_f32_32x32x16_bf16 v[128:143], v[116:119], v[112:115], v[128:143]
    v_mfma_f32_32x32x16_bf16 v[128:143], v[124:127], v[120:123], v[128:143]
    s_waitcnt lgkmcnt(0)
    s_lshl_b32 s38, s31, 7
    v_add_u32 v21, s38, v27
    s_add_u32 s31, s31, 1
    s_and_b32 s31, s31, 7
    s_lshl_b32 s38, s31, 7
    v_add_u32 v25, s38, v27
    s_add_u32 s31, s31, 1
    s_and_b32 s31, s31, 7
    s_barrier
    v_mfma_f32_32x32x16_bf16 v[128:143], v[36:39], v[32:35], v[128:143]
    ds_read_b128 v[64:67], v16 offset:32768
    ds_read_b128 v[68:71], v21 offset:0
    ds_read_b128 v[72:75], v17 offset:32768
    ds_read_b128 v[76:79], v21 offset:32
    ds_read_b128 v[80:83], v18 offset:32768
    ds_read_b128 v[84:87], v21 offset:64
    v_mfma_f32_32x32x16_bf16 v[128:143], v[44:47], v[40:43], v[128:143]
    ds_read_b128 v[88:91], v19 offset:32768
    ds_read_b128 v[92:95], v21 offset:96
    ds_read_b128 v[96:99], v16 offset:40960
    ds_read_b128 v[100:103], v25 offset:0
    ds_read_b128 v[104:107], v17 offset:40960
    v_mfma_f32_32x32x16_bf16 v[128:143], v[52:55], v[48:51], v[128:143]
    ds_read_b128 v[108:111], v25 offset:32
    ds_read_b128 v[112:115], v18 offset:40960
    ds_read_b128 v[116:119], v25 offset:64
    ds_read_b128 v[120:123], v19 offset:40960
    ds_read_b128 v[124:127], v25 offset:96
    v_mfma_f32_32x32x16_bf16 v[128:143], v[60:63], v[56:59], v[128:143]
    s_waitcnt lgkmcnt(8)
    v_mfma_f32_32x32x16_bf16 v[128:143], v[68:71], v[64:67], v[128:143]
    v_mfma_f32_32x32x16_bf16 v[128:143], v[76:79], v[72:75], v[128:143]
    v_mfma_f32_32x32x16_bf16 v[128:143], v[84:87], v[80:83], v[128:143]
    v_mfma_f32_32x32x16_bf16 v[128:143], v[92:95], v[88:91], v[128:143]
    s_waitcnt lgkmcnt(0)
    s_lshl_b32 s38, s31, 7
    v_add_u32 v21, s38, v27
    s_add_u32 s31, s31, 1
    s_and_b32 s31, s31, 7
    s_lshl_b32 s38, s31, 7
    v_add_u32 v25, s38, v27
    s_add_u32 s31, s31, 1
    s_and_b32 s31, s31, 7
    s_barrier
    v_mfma_f32_32x32x16_bf16 v[128:143], v[100:103], v[96:99], v[128:143]
    ds_read_b128 v[32:35], v16 offset:49152
    ds_read_b128 v[36:39], v21 offset:0
    ds_read_b128 v[40:43], v17 offset:49152
    ds_read_b128 v[44:47], v21 offset:32
    ds_read_b128 v[48:51], v18 offset:49152
    ds_read_b128 v[52:55], v21 offset:64
    v_mfma_f32_32x32x16_bf16 v[128:143], v[108:111], v[104:107], v[128:143]
    ds_read_b128 v[56:59], v19 offset:49152
    ds_read_b128 v[60:63], v21 offset:96
    ds_read_b128 v[64:67], v16 offset:57344
    ds_read_b128 v[68:71], v25 offset:0
    ds_read_b128 v[72:75], v17 offset:57344
    v_mfma_f32_32x32x16_bf16 v[128:143], v[116:119], v[112:115], v[128:143]
    ds_read_b128 v[76:79], v25 offset:32
    ds_read_b128 v[80:83], v18 offset:57344
    ds_read_b128 v[84:87], v25 offset:64
    ds_read_b128 v[88:91], v19 offset:57344
    ds_read_b128 v[92:95], v25 offset:96
    v_mfma_f32_32x32x16_bf16 v[128:143], v[124:127], v[120:123], v[128:143]
    s_waitcnt lgkmcnt(8)
    v_mfma_f32_32x32x16_bf16 v[128:143], v[36:39], v[32:35], v[128:143]
    v_mfma_f32_32x32x16_bf16 v[128:143], v[44:47], v[40:43], v[128:143]
    v_mfma_f32_32x32x16_bf16 v[128:143], v[52:55], v[48:51], v[128:143]
    v_mfma_f32_32x32x16_bf16 v[128:143], v[60:63], v[56:59], v[128:143]
    s_waitcnt lgkmcnt(0)
    s_barrier
    v_mfma_f32_32x32x16_bf16 v[128:143], v[68:71], v[64:67], v[128:143]
    v_mfma_f32_32x32x16_bf16 v[128:143], v[76:79], v[72:75], v[128:143]
    v_mfma_f32_32x32x16_bf16 v[128:143], v[84:87], v[80:83], v[128:143]
    v_mfma_f32_32x32x16_bf16 v[128:143], v[92:95], v[88:91], v[128:143]
    s_nop 11
    v_cvt_pk_bf16_f32 v11, v128, v128
    v_and_b32 v11, 0xffff0000, v11
    v_mul_f32 v11, s75, v11
    v_exp_f32 v11, v11
    s_nop 0
    v_add_f32 v11, 1.0, v11
    v_rcp_f32 v11, v11
    s_nop 0
    v_cvt_pk_bf16_f32 v11, v11, v11
    v_and_b32 v11, 0xffff0000, v11
    v_lshlrev_b32 v22, 2, v1
    s_lshl_b32 s38, s42, 7
    s_add_u32 s38, s38, 131072
    s_lshl_b32 s41, s42, 3
    s_add_u32 s41, s41, 148480
    s_mov_b32 exec_hi, 0
    buffer_store_dword v11, v22, s[24:27], s38 offen sc1
    s_mov_b64 exec, -1
    s_branch L_q5
L_touch:
L_touch7:
L_qidle:
    s_barrier
    s_barrier
    s_barrier
    s_barrier
    s_barrier
L_q5:
    s_load_dwordx2 s[78:79], s[72:73], 0x24800
    v_add_u32 v21, 131072, v20
    s_barrier
    s_barrier
    s_barrier
    s_cmp_eq_u32 s41, 0
    s_cbranch_scc1 L_noflag
    s_waitcnt lgkmcnt(0)
    s_add_u32 s78, s78, 1
    s_waitcnt vmcnt(0)
    v_mov_b32 v22, s78
    v_mov_b32 v23, s79
    v_mov_b32 v24, 0
    s_mov_b64 exec, 1
    buffer_store_dwordx2 v[22:23], v24, s[24:27], s41 offen sc1
    s_mov_b64 exec, -1
L_noflag:
    s_barrier
    s_barrier
    s_barrier
    s_barrier
    s_barrier
    ds_read_b128 v[32:35], v12 offset:0
    ds_read_b64_tr_b16 v[40:41], v21 offset:0
    ds_read_b64_tr_b16 v[42:43], v21 offset:512
    ds_read_b128 v[36:39], v12 offset:4096
    ds_read_b128 v[44:47], v13 offset:0
    ds_read_b64_tr_b16 v[52:53], v21 offset:2048
    ds_read_b64_tr_b16 v[54:55], v21 offset:2560
    ds_read_b128 v[48:51], v13 offset:4096
    ds_read_b128 v[56:59], v14 offset:0
    ds_read_b64_tr_b16 v[64:65], v21 offset:4096
    ds_read_b64_tr_b16 v[66:67], v21 offset:4608
    ds_read_b128 v[60:63], v14 offset:4096
    ds_read_b128 v[68:71], v15 offset:0
    ds_read_b64_tr_b16 v[76:77], v21 offset:6144
    ds_read_b64_tr_b16 v[78:79], v21 offset:6656
    ds_read_b128 v[72:75], v15 offset:4096
    s_setprio 1
    s_waitcnt lgkmcnt(0)
    s_barrier
    v_mfma_f32_32x32x16_bf16 v[96:111], v[40:43], v[32:35], 0
    ds_read_b128 v[80:83], v12 offset:8192
    ds_read_b64_tr_b16 v[88:89], v20 offset:16384
    ds_read_b64_tr_b16 v[90:91], v20 offset:16896
    ds_read_b128 v[84:87], v12 offset:12288
    v_mfma_f32_32x32x16_bf16 v[112:127], v[40:43], v[36:39], 0
    ds_read_b128 v[128:131], v13 offset:8192
    ds_read_b64_tr_b16 v[136:137], v20 offset:18432
    ds_read_b64_tr_b16 v[138:139], v20 offset:18944
    v_mfma_f32_32x32x16_bf16 v[96:111], v[52:55], v[44:47], v[96:111]
    ds_read_b128 v[132:135], v13 offset:12288
    ds_read_b128 v[92:95], v14 offset:8192
    ds_read_b64_tr_b16 v[16:17], v20 offset:20480
    v_mfma_f32_32x32x16_bf16 v[112:127], v[52:55], v[48:51], v[112:127]
    ds_read_b64_tr_b16 v[18:19], v20 offset:20992
    ds_read_b128 v[140:143], v14 offset:12288
    ds_read_b128 v[4:7], v15 offset:8192
    v_mfma_f32_32x32x16_bf16 v[96:111], v[64:67], v[56:59], v[96:111]
    ds_read_b64_tr_b16 v[164:165], v20 offset:22528
    ds_read_b64_tr_b16 v[166:167], v20 offset:23040
    ds_read_b128 v[160:163], v15 offset:12288
    v_mfma_f32_32x32x16_bf16 v[112:127], v[64:67], v[60:63], v[112:127]
    v_mfma_f32_32x32x16_bf16 v[96:111], v[76:79], v[68:71], v[96:111]
    v_mfma_f32_32x32x16_bf16 v[112:127], v[76:79], v[72:75], v[112:127]
    s_waitcnt lgkmcnt(0)
    s_barrier
    v_mfma_f32_32x32x16_bf16 v[96:111], v[88:91], v[80:83], v[96:111]
    ds_read_b128 v[32:35], v12 offset:16384
    ds_read_b64_tr_b16 v[40:41], v20 offset:32768
    ds_read_b64_tr_b16 v[42:43], v20 offset:33280
    ds_read_b128 v[36:39], v12 offset:20480
    v_mfma_f32_32x32x16_bf16 v[112:127], v[88:91], v[84:87], v[112:127]
    ds_read_b128 v[44:47], v13 offset:16384
    ds_read_b64_tr_b16 v[52:53], v20 offset:34816
    ds_read_b64_tr_b16 v[54:55], v20 offset:35328
    v_mfma_f32_32x32x16_bf16 v[96:111], v[136:139], v[128:131], v[96:111]
    ds_read_b128 v[48:51], v13 offset:20480
    ds_read_b128 v[56:59], v14 offset:16384
    ds_read_b64_tr_b16 v[64:65], v20 offset:36864
    v_mfma_f32_32x32x16_bf16 v[112:127], v[136:139], v[132:135], v[112:127]
    ds_read_b64_tr_b16 v[66:67], v20 offset:37376
    ds_read_b128 v[60:63], v14 offset:20480
    ds_read_b128 v[68:71], v15 offset:16384
    v_mfma_f32_32x32x16_bf16 v[96:111], v[16:19], v[92:95], v[96:111]
    ds_read_b64_tr_b16 v[76:77], v20 offset:38912
    ds_read_b64_tr_b16 v[78:79], v20 offset:39424
    ds_read_b128 v[72:75], v15 offset:20480
    v_mfma_f32_32x32x16_bf16 v[112:127], v[16:19], v[140:143], v[112:127]
    v_mfma_f32_32x32x16_bf16 v[96:111], v[164:167], v[4:7], v[96:111]
    v_mfma_f32_32x32x16_bf16 v[112:127], v[164:167], v[160:163], v[112:127]
    s_waitcnt lgkmcnt(0)
    s_barrier
    v_mfma_f32_32x32x16_bf16 v[96:111], v[40:43], v[32:35], v[96:111]
    ds_read_b128 v[80:83], v12 offset:24576
    ds_read_b64_tr_b16 v[88:89], v20 offset:49152
    ds_read_b64_tr_b16 v[90:91], v20 offset:49664
    ds_read_b128 v[84:87], v12 offset:28672
    v_mfma_f32_32x32x16_bf16 v[112:127], v[40:43], v[36:39], v[112:127]
    ds_read_b128 v[128:131], v13 offset:24576
    ds_read_b64_tr_b16 v[136:137], v20 offset:51200
    ds_read_b64_tr_b16 v[138:139], v20 offset:51712
    v_mfma_f32_32x32x16_bf16 v[96:111], v[52:55], v[44:47], v[96:111]
    ds_read_b128 v[132:135], v13 offset:28672
    ds_read_b128 v[92:95], v14 offset:24576
    ds_read_b64_tr_b16 v[16:17], v20 offset:53248
    v_mfma_f32_32x32x16_bf16 v[112:127], v[52:55], v[48:51], v[112:127]
    ds_read_b64_tr_b16 v[18:19], v20 offset:53760
    ds_read_b128 v[140:143], v14 offset:28672
    ds_read_b128 v[4:7], v15 offset:24576
    v_mfma_f32_32x32x16_bf16 v[96:111], v[64:67], v[56:59], v[96:111]
    ds_read_b64_tr_b16 v[164:165], v20 offset:55296
    ds_read_b64_tr_b16 v[166:167], v20 offset:55808
    ds_read_b128 v[160:163], v15 offset:28672
    v_mfma_f32_32x32x16_bf16 v[112:127], v[64:67], v[60:63], v[112:127]
    v_mfma_f32_32x32x16_bf16 v[96:111], v[76:79], v[68:71], v[96:111]
    v_mfma_f32_32x32x16_bf16 v[112:127], v[76:79], v[72:75], v[112:127]
    s_waitcnt lgkmcnt(0)
    s_barrier
    v_mfma_f32_32x32x16_bf16 v[96:111], v[88:91], v[80:83], v[96:111]
    ds_read_b128 v[32:35], v12 offset:32768
    ds_read_b64_tr_b16 v[40:41], v20 offset:0
    ds_read_b64_tr_b16 v[42:43], v20 offset:512
    ds_read_b128 v[36:39], v12 offset:36864
    v_mfma_f32_32x32x16_bf16 v[112:127], v[88:91], v[84:87], v[112:127]
    ds_read_b128 v[44:47], v13 offset:32768
    ds_read_b64_tr_b16 v[52:53], v20 offset:2048
    ds_read_b64_tr_b16 v[54:55], v20 offset:2560
    v_mfma_f32_32x32x16_bf16 v[96:111], v[136:139], v[128:131], v[96:111]
    ds_read_b128 v[48:51], v13 offset:36864
    ds_read_b128 v[56:59], v14 offset:32768
    ds_read_b64_tr_b16 v[64:65], v20 offset:4096
    v_mfma_f32_32x32x16_bf16 v[112:127], v[136:139], v[132:135], v[112:127]
    ds_read_b64_tr_b16 v[66:67], v20 offset:4608
    ds_read_b128 v[60:63], v14 offset:36864
    ds_read_b128 v[68:71], v15 offset:32768
    v_mfma_f32_32x32x16_bf16 v[96:111], v[16:19], v[92:95], v[96:111]
    ds_read_b64_tr_b16 v[76:77], v20 offset:6144
    ds_read_b64_tr_b16 v[78:79], v20 offset:6656
    ds_read_b128 v[72:75], v15 offset:36864
    v_mfma_f32_32x32x16_bf16 v[112:127], v[16:19], v[140:143], v[112:127]
    v_mfma_f32_32x32x16_bf16 v[96:111], v[164:167], v[4:7], v[96:111]
    v_mfma_f32_32x32x16_bf16 v[112:127], v[164:167], v[160:163], v[112:127]
    s_waitcnt lgkmcnt(0)
    s_barrier
    v_mfma_f32_32x32x16_bf16 v[96:111], v[40:43], v[32:35], v[96:111]
    ds_read_b128 v[80:83], v12 offset:40960
    ds_read_b64_tr_b16 v[88:89], v20 offset:16384
    ds_read_b64_tr_b16 v[90:91], v20 offset:16896
    ds_read_b128 v[84:87], v12 offset:45056
    v_mfma_f32_32x32x16_bf16 v[112:127], v[40:43], v[36:39], v[112:127]
    ds_read_b128 v[128:131], v13 offset:40960
    ds_read_b64_tr_b16 v[136:137], v20 offset:18432
    ds_read_b64_tr_b16 v[138:139], v20 offset:18944
    v_mfma_f32_32x32x16_bf16 v[96:111], v[52:55], v[44:47], v[96:111]
    ds_read_b128 v[132:135], v13 offset:45056
    ds_read_b128 v[92:95], v14 offset:40960
    ds_read_b64_tr_b16 v[16:17], v20 offset:20480
    v_mfma_f32_32x32x16_bf16 v[112:127], v[52:55], v[48:51], v[112:127]
    ds_read_b64_tr_b16 v[18:19], v20 offset:20992
    ds_read_b128 v[140:143], v14 offset:45056
    ds_read_b128 v[4:7], v15 offset:40960
    v_mfma_f32_32x32x16_bf16 v[96:111], v[64:67], v[56:59], v[96:111]
    ds_read_b64_tr_b16 v[164:165], v20 offset:22528
    ds_read_b64_tr_b16 v[166:167], v20 offset:23040
    ds_read_b128 v[160:163], v15 offset:45056
    v_mfma_f32_32x32x16_bf16 v[112:127], v[64:67], v[60:63], v[112:127]
    v_mfma_f32_32x32x16_bf16 v[96:111], v[76:79], v[68:71], v[96:111]
    v_mfma_f32_32x32x16_bf16 v[112:127], v[76:79], v[72:75], v[112:127]
    s_waitcnt lgkmcnt(0)
    s_barrier
    v_mfma_f32_32x32x16_bf16 v[96:111], v[88:91], v[80:83], v[96:111]
    ds_read_b128 v[32:35], v12 offset:49152
    ds_read_b64_tr_b16 v[40:41], v20 offset:32768
    ds_read_b64_tr_b16 v[42:43], v20 offset:33280
    ds_read_b128 v[36:39], v12 offset:53248
    v_mfma_f32_32x32x16_bf16 v[112:127], v[88:91], v[84:87], v[112:127]
    ds_read_b128 v[44:47], v13 offset:49152
    ds_read_b64_tr_b16 v[52:53], v20 offset:34816
    ds_read_b64_tr_b16 v[54:55], v20 offset:35328
    v_mfma_f32_32x32x16_bf16 v[96:111], v[136:139], v[128:131], v[96:111]
    ds_read_b128 v[48:51], v13 offset:53248
    ds_read_b128 v[56:59], v14 offset:49152
    ds_read_b64_tr_b16 v[64:65], v20 offset:36864
    v_mfma_f32_32x32x16_bf16 v[112:127], v[136:139], v[132:135], v[112:127]
    ds_read_b64_tr_b16 v[66:67], v20 offset:37376
    ds_read_b128 v[60:63], v14 offset:53248
    ds_read_b128 v[68:71], v15 offset:49152
    v_mfma_f32_32x32x16_bf16 v[96:111], v[16:19], v[92:95], v[96:111]
    ds_read_b64_tr_b16 v[76:77], v20 offset:38912
    ds_read_b64_tr_b16 v[78:79], v20 offset:39424
    ds_read_b128 v[72:75], v15 offset:53248
    v_mfma_f32_32x32x16_bf16 v[112:127], v[16:19], v[140:143], v[112:127]
    v_mfma_f32_32x32x16_bf16 v[96:111], v[164:167], v[4:7], v[96:111]
    v_mfma_f32_32x32x16_bf16 v[112:127], v[164:167], v[160:163], v[112:127]
    s_waitcnt lgkmcnt(0)
    s_barrier
    v_mfma_f32_32x32x16_bf16 v[96:111], v[40:43], v[32:35], v[96:111]
    ds_read_b128 v[80:83], v12 offset:57344
    ds_read_b64_tr_b16 v[88:89], v20 offset:49152
    ds_read_b64_tr_b16 v[90:91], v20 offset:49664
    ds_read_b128 v[84:87], v12 offset:61440
    v_mfma_f32_32x32x16_bf16 v[112:127], v[40:43], v[36:39], v[112:127]
    ds_read_b128 v[128:131], v13 offset:57344
    ds_read_b64_tr_b16 v[136:137], v20 offset:51200
    ds_read_b64_tr_b16 v[138:139], v20 offset:51712
    v_mfma_f32_32x32x16_bf16 v[96:111], v[52:55], v[44:47], v[96:111]
    ds_read_b128 v[132:135], v13 offset:61440
    ds_read_b128 v[92:95], v14 offset:57344
    ds_read_b64_tr_b16 v[16:17], v20 offset:53248
    v_mfma_f32_32x32x16_bf16 v[112:127], v[52:55], v[48:51], v[112:127]
    ds_read_b64_tr_b16 v[18:19], v20 offset:53760
    ds_read_b128 v[140:143], v14 offset:61440
    ds_read_b128 v[4:7], v15 offset:57344
    v_mfma_f32_32x32x16_bf16 v[96:111], v[64:67], v[56:59], v[96:111]
    ds_read_b64_tr_b16 v[164:165], v20 offset:55296
    ds_read_b64_tr_b16 v[166:167], v20 offset:55808
    ds_read_b128 v[160:163], v15 offset:61440
    v_mfma_f32_32x32x16_bf16 v[112:127], v[64:67], v[60:63], v[112:127]
    v_mfma_f32_32x32x16_bf16 v[96:111], v[76:79], v[68:71], v[96:111]
    v_mfma_f32_32x32x16_bf16 v[112:127], v[76:79], v[72:75], v[112:127]
    s_waitcnt lgkmcnt(0)
    v_mfma_f32_32x32x16_bf16 v[112:127], v[88:91], v[84:87], v[112:127]
    v_mfma_f32_32x32x16_bf16 v[112:127], v[136:139], v[132:135], v[112:127]
    v_mfma_f32_32x32x16_bf16 v[112:127], v[16:19], v[140:143], v[112:127]
    v_mfma_f32_32x32x16_bf16 v[112:127], v[164:167], v[160:163], v[112:127]
    v_mfma_f32_32x32x16_bf16 v[96:111], v[88:91], v[80:83], v[96:111]
    v_mfma_f32_32x32x16_bf16 v[96:111], v[136:139], v[128:131], v[96:111]
    s_nop 7
    s_nop 1
    v_mul_f32 v120, s76, v120
    v_mul_f32 v121, s76, v121
    v_mul_f32 v122, s76, v122
    v_mul_f32 v123, s76, v123
    v_mul_f32 v124, s76, v124
    v_mul_f32 v125, s76, v125
    v_mul_f32 v126, s76, v126
    v_mul_f32 v127, s76, v127
    v_mfma_f32_32x32x16_bf16 v[96:111], v[16:19], v[92:95], v[96:111]
    v_cvt_pk_bf16_f32 v76, v120, v121
    v_cvt_pk_bf16_f32 v77, v122, v123
    v_cvt_pk_bf16_f32 v78, v124, v125
    v_cvt_pk_bf16_f32 v79, v126, v127
    ds_write_b128 v28, v[76:79]
    v_cvt_pk_bf16_f32 v72, v112, v113
    v_mfma_f32_32x32x16_bf16 v[96:111], v[164:167], v[4:7], v[96:111]
    v_cvt_pk_bf16_f32 v73, v114, v115
    v_cvt_pk_bf16_f32 v74, v116, v117
    v_cvt_pk_bf16_f32 v75, v118, v119
    ds_write_b128 v29, v[72:75] offset:1024
    s_nop 7
    v_cvt_pk_bf16_f32 v64, v96, v97
    v_cvt_pk_bf16_f32 v65, v98, v99
    v_cvt_pk_bf16_f32 v66, v100, v101
    v_cvt_pk_bf16_f32 v67, v102, v103
    ds_write_b128 v29, v[64:67] offset:0
    v_pk_mul_f32 v[104:105], v[104:105], s[76:77] op_sel_hi:[1,0]
    v_pk_mul_f32 v[106:107], v[106:107], s[76:77] op_sel_hi:[1,0]
    v_pk_mul_f32 v[108:109], v[108:109], s[76:77] op_sel_hi:[1,0]
    v_pk_mul_f32 v[110:111], v[110:111], s[76:77] op_sel_hi:[1,0]
    v_cvt_pk_bf16_f32 v4, v104, v105
    v_cvt_pk_bf16_f32 v5, v106, v107
    v_cvt_pk_bf16_f32 v6, v108, v109
    v_cvt_pk_bf16_f32 v7, v110, v111
    s_waitcnt lgkmcnt(0)
    s_barrier
L_attn:
    s_setprio 2
    ds_read_b128 v[80:83], v2
    ds_read_b128 v[84:87], v2 offset:2048
    s_mov_b64 exec, s[20:21]
    ds_read_b128 v[144:147], v2 offset:1024
    ds_read_b128 v[148:151], v2 offset:1280
    s_mov_b64 exec, -1
    v_mov_b64 v[24:25], 0
    v_mov_b64 v[26:27], 0
    v_mov_b64 v[28:29], 0
    v_mov_b64 v[30:31], 0
    v_mov_b64 v[32:33], 0
    v_mov_b64 v[34:35], 0
    v_mov_b64 v[36:37], 0
    v_mov_b64 v[38:39], 0
    s_waitcnt lgkmcnt(0)
    v_mfma_f32_32x32x16_bf16 v[40:55], v[80:83], v[4:7], 0
    v_mfma_f32_32x32x16_bf16 v[56:71], v[84:87], v[4:7], 0
    s_nop 10
    v_max3_f32 v106, v40, v41, v42
    v_max3_f32 v107, v43, v44, v45
    v_max3_f32 v106, v106, v46, v47
    v_max3_f32 v107, v107, v48, v49
    v_max3_f32 v106, v106, v50, v51
    v_max3_f32 v107, v107, v52, v53
    v_max3_f32 v106, v106, v54, v55
    v_max3_f32 v107, v107, v56, v57
    v_max3_f32 v106, v106, v58, v59
    v_max3_f32 v107, v107, v60, v61
    v_max3_f32 v106, v106, v62, v63
    v_max3_f32 v107, v107, v64, v65
    v_max3_f32 v106, v106, v66, v67
    v_max3_f32 v107, v107, v68, v69
    v_max3_f32 v106, v106, v70, v71
    v_max_f32 v106, v106, v107
    v_mov_b32 v107, v106
    s_nop 1
    v_permlane32_swap_b32 v106, v107
    s_nop 2
    v_max_f32 v106, v106, v107
    v_sub_f32 v8, 0xc1a00000, v106
    v_sub_f32 v9, 0xc1a00000, v106
    v_mov_b64 v[10:11], v[8:9]
    v_mov_b64 v[12:13], v[8:9]
    v_mov_b64 v[14:15], v[8:9]
    v_mov_b64 v[16:17], v[8:9]
    v_mov_b64 v[18:19], v[8:9]
    v_mov_b64 v[20:21], v[8:9]
    v_mov_b64 v[22:23], v[8:9]
    s_nop 1
    v_mfma_f32_32x32x16_bf16 v[40:55], v[80:83], v[4:7], v[8:23]
    v_mov_b64 v[64:65], 0
    v_mov_b64 v[66:67], 0
    v_mov_b64 v[68:69], 0
    v_mov_b64 v[70:71], 0
    s_nop 7
.p2align 6
L_loop:
    v_exp_f32 v40, v40
    v_exp_f32 v41, v41
    v_smfmac_f32_32x32x32_bf16 v[24:39], v[156:159], v[64:71], v3
    s_mov_b64 exec, s[20:21]
    ds_read_b128 v[152:155], v2 offset:3072
    ds_read_b128 v[156:159], v2 offset:3328
    s_mov_b64 exec, -1
    v_exp_f32 v42, v42
    v_exp_f32 v43, v43
    s_waitcnt lgkmcnt(2)
    v_mfma_f32_32x32x16_bf16 v[56:71], v[84:87], v[4:7], v[8:23]
    ds_read_b128 v[80:83], v2 offset:4096
    v_exp_f32 v44, v44
    v_exp_f32 v45, v45
    v_exp_f32 v46, v46
    v_exp_f32 v47, v47
    v_exp_f32 v48, v48
    v_exp_f32 v49, v49
    v_smfmac_f32_32x32x32_bf16 v[24:39], v[144:147], v[40:47], v3
    v_exp_f32 v50, v50
    v_exp_f32 v51, v51
    v_exp_f32 v52, v52
    v_exp_f32 v53, v53
    v_exp_f32 v54, v54
    v_exp_f32 v55, v55
    v_exp_f32 v56, v56
    v_exp_f32 v57, v57
    v_smfmac_f32_32x32x32_bf16 v[24:39], v[148:151], v[48:55], v3
    s_mov_b64 exec, s[20:21]
    ds_read_b128 v[144:147], v2 offset:5120
    ds_read_b128 v[148:151], v2 offset:5376
    s_mov_b64 exec, -1
    v_exp_f32 v58, v58
    v_exp_f32 v59, v59
    s_waitcnt lgkmcnt(2)
    v_mfma_f32_32x32x16_bf16 v[40:55], v[80:83], v[4:7], v[8:23]
    ds_read_b128 v[84:87], v2 offset:6144
    v_exp_f32 v60, v60
    v_exp_f32 v61, v61
    v_exp_f32 v62, v62
    v_exp_f32 v63, v63
    v_exp_f32 v64, v64
    v_exp_f32 v65, v65
    v_smfmac_f32_32x32x32_bf16 v[24:39], v[152:155], v[56:63], v3
    v_exp_f32 v66, v66
    v_exp_f32 v67, v67
    v_exp_f32 v68, v68
    v_exp_f32 v69, v69
    v_exp_f32 v70, v70
    v_exp_f32 v71, v71
    v_exp_f32 v40, v40
    v_exp_f32 v41, v41
    v_smfmac_f32_32x32x32_bf16 v[24:39], v[156:159], v[64:71], v3
    s_mov_b64 exec, s[20:21]
    ds_read_b128 v[152:155], v2 offset:7168
    ds_read_b128 v[156:159], v2 offset:7424
    s_mov_b64 exec, -1
    v_exp_f32 v42, v42
    v_exp_f32 v43, v43
    s_waitcnt lgkmcnt(2)
    v_mfma_f32_32x32x16_bf16 v[56:71], v[84:87], v[4:7], v[8:23]
    ds_read_b128 v[80:83], v2 offset:8192
    v_exp_f32 v44, v44
    v_exp_f32 v45, v45
    v_exp_f32 v46, v46
    v_exp_f32 v47, v47
    v_exp_f32 v48, v48
    v_exp_f32 v49, v49
    v_smfmac_f32_32x32x32_bf16 v[24:39], v[144:147], v[40:47], v3
    v_exp_f32 v50, v50
    v_exp_f32 v51, v51
    v_exp_f32 v52, v52
    v_exp_f32 v53, v53
    v_exp_f32 v54, v54
    v_exp_f32 v55, v55
    v_exp_f32 v56, v56
    v_exp_f32 v57, v57
    v_smfmac_f32_32x32x32_bf16 v[24:39], v[148:151], v[48:55], v3
    s_mov_b64 exec, s[20:21]
    ds_read_b128 v[144:147], v2 offset:9216
    ds_read_b128 v[148:151], v2 offset:9472
    s_mov_b64 exec, -1
    v_exp_f32 v58, v58
    v_exp_f32 v59, v59
    s_waitcnt lgkmcnt(2)
    v_mfma_f32_32x32x16_bf16 v[40:55], v[80:83], v[4:7], v[8:23]
    ds_read_b128 v[84:87], v2 offset:10240
    v_exp_f32 v60, v60
    v_exp_f32 v61, v61
    v_exp_f32 v62, v62
    v_exp_f32 v63, v63
    v_exp_f32 v64, v64
    v_exp_f32 v65, v65
    v_smfmac_f32_32x32x32_bf16 v[24:39], v[152:155], v[56:63], v3
    v_add_u32 v2, 8192, v2
    s_add_u32 s23, s23, 1
    s_cmp_lt_u32 s23, s22
    v_exp_f32 v66, v66
    v_exp_f32 v67, v67
    v_exp_f32 v68, v68
    v_exp_f32 v69, v69
    v_exp_f32 v70, v70
    v_exp_f32 v71, v71
    s_cbranch_scc1 L_loop
    s_cmp_lg_u32 s22, 16
    s_cbranch_scc1 L_seg
    v_smfmac_f32_32x32x32_bf16 v[24:39], v[156:159], v[64:71], v3
    v_lshlrev_b32 v2, 4, v1
    s_nop 10
    v_fma_f32 v107, v24, 0, v32
    v_mul_f32 v109, 0, v25
    v_rcp_f32 v106, v32
    v_fma_f32 v107, v26, 0, v107
    v_fma_f32 v109, v27, 0, v109
    v_fma_f32 v107, v28, 0, v107
    v_fma_f32 v109, v29, 0, v109
    v_fma_f32 v107, v30, 0, v107
    v_fma_f32 v109, v31, 0, v109
    v_max3_f32 v110, |v24|, |v25|, |v26|
    v_max3_f32 v111, |v27|, |v28|, |v29|
    v_add_f32 v107, v107, v109
    v_max3_f32 v110, v110, |v30|, |v31|
    v_cmp_ngt_f32 s[36:37], s39, v107
    v_max_f32 v110, v110, v111
    v_add_u32 v110, -1, v110
    v_cmp_gt_u32 vcc, 0x0f800000, v110
    s_nop 0
    s_or_b64 vcc, vcc, s[36:37]
    s_cbranch_scc1 L_fallback
L_fin:
    v_pk_mul_f32 v[24:25], v[24:25], v[106:107] op_sel_hi:[1,0]
    v_pk_mul_f32 v[26:27], v[26:27], v[106:107] op_sel_hi:[1,0]
    v_pk_mul_f32 v[28:29], v[28:29], v[106:107] op_sel_hi:[1,0]
    v_pk_mul_f32 v[30:31], v[30:31], v[106:107] op_sel_hi:[1,0]
    v_pk_mul_f32 v[24:25], v[24:25], v[108:109] op_sel_hi:[1,0]
    v_pk_mul_f32 v[26:27], v[26:27], v[108:109] op_sel_hi:[1,0]
    v_pk_mul_f32 v[28:29], v[28:29], v[108:109] op_sel_hi:[1,0]
    v_pk_mul_f32 v[30:31], v[30:31], v[108:109] op_sel_hi:[1,0]
    v_cvt_pk_bf16_f32 v24, v24, v25
    v_cvt_pk_bf16_f32 v25, v26, v27
    v_cvt_pk_bf16_f32 v26, v28, v29
    v_cvt_pk_bf16_f32 v27, v30, v31
L_far:
    buffer_store_dwordx4 v[24:27], v2, s[24:27], s43 offen sc1
    s_waitcnt lgkmcnt(0)
    s_barrier
L_cend:
    s_endpgm
L_seg:
    s_cmp_eq_u32 s22, 9
    s_cbranch_scc1 L_seg1
    s_cmp_gt_u32 s22, 9
    s_cbranch_scc1 L_seg2
    s_cmp_lg_u32 s22, 2
    s_cbranch_scc1 L_segf
    v_mov_b32 v106, 157696
    s_mov_b32 s77, 0
LW_15:
    ds_read_b32 v107, v106
    s_add_u32 s77, s77, 1
    s_waitcnt lgkmcnt(0)
    v_cmp_gt_u32 vcc, 4, v107
    s_cbranch_vccz LD_16
    s_cmp_gt_u32 s77, 524288
    s_cbranch_scc1 LD_16
    s_sleep 1
    s_branch LW_15
LD_16:
    s_mov_b32 s22, 9
    s_cmp_lg_u32 s40, 0
    s_cbranch_scc1 L_loop
    v_and_b32 v112, 31, v1
    v_lshlrev_b32 v112, 4, v112
    v_lshrrev_b32 v113, 5, v1
    v_lshl_add_u32 v112, v113, 14, v112
    s_lshl_b32 s38, s45, 17
    s_lshl_b32 s39, s28, 9
    s_add_u32 s38, s38, s39
    s_add_u32 s38, s38, 1048576
    s_mov_b32 exec_lo, 0x1ffff
    s_mov_b32 exec_hi, 0x1ffff
    buffer_store_dwordx4 v[128:131], v112, s[24:27], s38 offen sc1
    s_add_u32 s38, s38, 32768
    buffer_store_dwordx4 v[132:135], v112, s[24:27], s38 offen sc1
    s_add_u32 s38, s38, 32768
    buffer_store_dwordx4 v[136:139], v112, s[24:27], s38 offen sc1
    s_add_u32 s38, s38, 32768
    buffer_store_dwordx4 v[140:143], v112, s[24:27], s38 offen sc1
    s_mov_b64 exec, -1
    s_mov_b32 s22, 4
    s_branch L_loop
L_segf:
    s_mov_b32 s22, 9
    s_lshl_b32 s38, s45, 5
    s_add_u32 s38, s38, s28
    s_lshl_b32 s38, s38, 3
    s_add_u32 s38, s38, 151552
    s_waitcnt vmcnt(0)
    v_mov_b32 v106, s78
    v_mov_b32 v107, s79
    v_mov_b32 v108, 0
    s_mov_b64 exec, 1
    buffer_store_dwordx2 v[106:107], v108, s[24:27], s38 offen sc1
    s_mov_b64 exec, -1
L_seg0b:
    s_branch L_loop
L_seg1:
    s_mov_b32 s22, 15
    v_mov_b32 v106, 157700
    v_mov_b32 v107, 1
    s_mov_b64 exec, 1
    ds_add_u32 v106, v107
    s_mov_b64 exec, -1
    v_mov_b32 v106, 157708
    s_mov_b32 s77, 0
LW_17:
    ds_read_b32 v107, v106
    s_add_u32 s77, s77, 1
    s_waitcnt lgkmcnt(0)
    v_cmp_gt_u32 vcc, 4, v107
    s_cbranch_vccz LD_18
    s_cmp_gt_u32 s77, 524288
    s_cbranch_scc1 LD_18
    s_sleep 4
    s_branch LW_17
LD_18:
    s_lshl_b32 s38, s46, 7
    s_add_u32 s38, s38, 157760
    v_and_b32 v106, 31, v1
    v_lshl_add_u32 v106, v106, 2, s38
    ds_read_b32 v108, v106
    s_mov_b32 s39, 0x7d800000
    s_waitcnt lgkmcnt(0)
    v_sub_f32 v108, 1.0, v108
    v_cvt_pk_bf16_f32 v108, v108, v108
    v_and_b32 v108, 0xffff0000, v108
    s_cmp_lg_u32 s40, 0
    s_cbranch_scc1 L_loop
    s_setprio 1
    s_mov_b32 s22, 16
    s_branch L_loop
L_seg2:
    s_mov_b32 s22, 16
    s_setprio 1
    s_cmp_lg_u32 s40, 0
    s_cbranch_scc1 L_loop
    s_setprio 0
    s_branch L_loop
L_fallback:
    s_waitcnt lgkmcnt(0)
    v_mov_b32 v106, 0xff800000
    s_mov_b32 s38, 0
L_fb1:
    buffer_load_dwordx4 v[80:83], v2, s[24:27], s38 offen sc1
    s_add_u32 s38, s38, 2048
    s_waitcnt vmcnt(0)
    v_mfma_f32_32x32x16_bf16 v[40:55], v[80:83], v[4:7], 0
    s_nop 11
    v_max3_f32 v106, v106, v40, v41
    v_max3_f32 v106, v106, v42, v43
    v_max3_f32 v106, v106, v44, v45
    v_max3_f32 v106, v106, v46, v47
    v_max3_f32 v106, v106, v48, v49
    v_max3_f32 v106, v106, v50, v51
    v_max3_f32 v106, v106, v52, v53
    v_max3_f32 v106, v106, v54, v55
    s_cmp_lt_u32 s38, 0x20000
    s_cbranch_scc1 L_fb1
    v_mov_b32 v107, v106
    s_nop 1
    v_permlane32_swap_b32 v106, v107
    s_nop 2
    v_max_f32 v106, v106, v107
    v_sub_f32 v8, 0, v106
    v_sub_f32 v9, 0, v106
    v_mov_b64 v[10:11], v[8:9]
    v_mov_b64 v[12:13], v[8:9]
    v_mov_b64 v[14:15], v[8:9]
    v_mov_b64 v[16:17], v[8:9]
    v_mov_b64 v[18:19], v[8:9]
    v_mov_b64 v[20:21], v[8:9]
    v_mov_b64 v[22:23], v[8:9]
    v_mov_b32 v24, 0
    v_mov_b32 v25, 0
    v_mov_b32 v26, 0
    v_mov_b32 v27, 0
    v_mov_b32 v28, 0
    v_mov_b32 v29, 0
    v_mov_b32 v30, 0
    v_mov_b32 v31, 0
    v_mov_b32 v32, 0
    v_mov_b32 v33, 0
    v_mov_b32 v34, 0
    v_mov_b32 v35, 0
    v_mov_b32 v36, 0
    v_mov_b32 v37, 0
    v_mov_b32 v38, 0
    v_mov_b32 v39, 0
    s_mov_b32 s38, 0
L_fb2:
    buffer_load_dwordx4 v[80:83], v2, s[24:27], s38 offen sc1
    s_mov_b64 exec, s[20:21]
    buffer_load_dwordx4 v[144:147], v2, s[24:27], s38 offen offset:1024 sc1
    buffer_load_dwordx4 v[148:151], v2, s[24:27], s38 offen offset:1280 sc1
    s_mov_b64 exec, -1
    s_add_u32 s38, s38, 2048
    s_waitcnt vmcnt(0)
    v_mfma_f32_32x32x16_bf16 v[40:55], v[80:83], v[4:7], v[8:23]
    s_nop 11
    v_exp_f32 v40, v40
    v_exp_f32 v41, v41
    v_exp_f32 v42, v42
    v_exp_f32 v43, v43
    v_exp_f32 v44, v44
    v_exp_f32 v45, v45
    v_exp_f32 v46, v46
    v_exp_f32 v47, v47
    v_exp_f32 v48, v48
    v_exp_f32 v49, v49
    v_exp_f32 v50, v50
    v_exp_f32 v51, v51
    v_exp_f32 v52, v52
    v_exp_f32 v53, v53
    v_exp_f32 v54, v54
    v_exp_f32 v55, v55
    v_smfmac_f32_32x32x32_bf16 v[24:39], v[144:147], v[40:47], v3
    s_nop 0
    v_smfmac_f32_32x32x32_bf16 v[24:39], v[148:151], v[48:55], v3
    s_nop 7
    s_cmp_lt_u32 s38, 0x20000
    s_cbranch_scc1 L_fb2
    s_nop 7
    s_nop 7
    v_rcp_f32 v106, v32
    s_branch L_fin
.section .rodata,"a"
.p2align 6
.amdhsa_kernel gated_mix__linear_kernel_hedgehog__grouped_kv_mqa__prompt_kernel
  .amdhsa_next_free_vgpr 168
  .amdhsa_next_free_sgpr 80
  .amdhsa_accum_offset 168
  .amdhsa_group_segment_fixed_size 0
  .amdhsa_kernarg_size 104
  .amdhsa_user_sgpr_count 2
  .amdhsa_user_sgpr_kernarg_segment_ptr 1
  .amdhsa_system_sgpr_workgroup_id_x 1
.end_amdhsa_kernel
```
